```python
import torch

def _softmax(x, axis=-1):
    return torch.softmax(x, dim=axis)
def _gelu(x):
    return torch.nn.functional.gelu(x, approximate="tanh")
def _silu(x):
    return torch.nn.functional.silu(x)
def _sigmoid(x):
    return torch.sigmoid(x)
def _layernorm(x, axis=-1, eps=1e-5):
    m = x.mean(dim=axis, keepdim=True)
    v = x.var(dim=axis, keepdim=True, unbiased=False)
    return (x - m) / torch.sqrt(v + eps)
def _scatter_add(tgt, idx, src, axis=0):
    return tgt.clone().index_add_(axis, idx, src)
def _segment_sum(src, seg, n):
    out = torch.zeros((n,) + src.shape[1:], dtype=src.dtype)
    return out.index_add_(0, seg, src)
def _pad(x, pw):
    flat = tuple(v for pair in reversed(pw) for v in pair)
    return torch.nn.functional.pad(x, flat)

kernel_name = 'sequential_preLN__mha_block_cached__swiglu_ffn__decode'

def setup_inputs():

    _w = (lambda a: (lambda t: t.to(torch.bfloat16) if t.is_floating_point() else t)(torch.as_tensor(a)))
    def _A_setup():
        B, Sq, D = 1, 1, 640
        H, Sk, Dh = 32, 32768, 192
        return {
            "x": _w((lambda *s: torch.randn(*s, dtype=torch.bfloat16) * 0.05)(B, Sq, D)),
            "k_cache": _w((lambda *s: torch.randn(*s, dtype=torch.bfloat16) * 3.2)(B, H, Sk, Dh)),
            "v_cache": _w((lambda *s: torch.randn(*s, dtype=torch.bfloat16) * 0.4)(B, H, Sk, Dh)),
            "wq": _w((lambda *s: torch.randn(*s, dtype=torch.bfloat16) * 3.2)(D, H * Dh) * (D ** -0.5)),
            "wo": _w((lambda *s: torch.randn(*s, dtype=torch.bfloat16) * 0.4)(H * Dh, D) * ((H * Dh) ** -0.5)),
        }
    _A_in = _A_setup()

    def _B_setup():
        B, S, D, F = 1, 1, 640, 1536
        return {
            "x": _w((lambda *s: torch.randn(*s, dtype=torch.bfloat16) * 0.05)(B, S, D)),
            "w_gate": _w((lambda *s: torch.randn(*s, dtype=torch.bfloat16) * 0.05)(D, F)),
            "w_up": _w((lambda *s: torch.randn(*s, dtype=torch.bfloat16) * 0.05)(D, F)),
            "w_down": _w((lambda *s: torch.randn(*s, dtype=torch.bfloat16) * 0.05)(F, D)),
        }
    _B_in = _B_setup()

    return {
        "A_x": _A_in["x"],
        "A_k_cache": _A_in["k_cache"],
        "A_v_cache": _A_in["v_cache"],
        "A_wq": _A_in["wq"],
        "A_wo": _A_in["wo"],
        "B_x": _B_in["x"],
        "B_w_gate": _B_in["w_gate"],
        "B_w_up": _B_in["w_up"],
        "B_w_down": _B_in["w_down"],
    }

def reference(A_x, A_k_cache, A_v_cache, A_wq, A_wo, B_x, B_w_gate, B_w_up, B_w_down):
    def _A_ref(x, k_cache, v_cache, wq, wo):
        B, Sq, D = x.shape
        H, Dh = 32, 192
        q = (lambda x, *d: x.permute(*d))((x @ wq).reshape(B, Sq, H, Dh), 0, 2, 1, 3)
        scores = torch.einsum("bhqd,bhkd->bhqk", q, k_cache) * (Dh ** -0.5)
        p = _softmax(scores, axis=-1)
        o = torch.einsum("bhqk,bhkd->bhqd", p, v_cache)
        return (lambda x, *d: x.permute(*d))(o, 0, 2, 1, 3).reshape(B, Sq, H * Dh) @ wo

    def _B_ref(x, w_gate, w_up, w_down):
        g = _silu(x @ w_gate)
        u = x @ w_up
        return (g * u) @ w_down

    x = A_x
    h = x + _A_ref(_layernorm(x, axis=-1), A_k_cache, A_v_cache, A_wq, A_wo)
    h2 = h + _B_ref(_layernorm(h, axis=-1), B_w_gate, B_w_up, B_w_down)
    return h2
```

```asm
; @launch grid=(256,1,1) block=(384,1,1) lds=156160
.amdgcn_target "amdgcn-amd-amdhsa--gfx950"
.text
.globl sequential_preLN__mha_block_cached__swiglu_ffn__decode_kernel
.p2align 8
.type sequential_preLN__mha_block_cached__swiglu_ffn__decode_kernel,@function
sequential_preLN__mha_block_cached__swiglu_ffn__decode_kernel:
    s_cmp_ge_u32 s2, 256
    s_cbranch_scc1 L_exit
    s_load_dwordx16 s[4:19], s[0:1], 0
    s_load_dwordx8 s[20:27], s[0:1], 64
    v_lshrrev_b32 v2, 6, v0
    v_and_b32 v1, 63, v0
    v_readfirstlane_b32 s30, v2
    s_and_b32 s28, s2, 7
    s_lshr_b32 s29, s2, 3
    s_mov_b32 s44, 2097152
    s_mov_b32 s42, 0x05040100
    s_mov_b32 s43, 0x07060302
    v_lshrrev_b32 v7, 3, v1
    v_and_b32 v8, 7, v1
    v_lshlrev_b32 v4, 2, v1
    s_mul_i32 s77, s29, 5
    s_add_u32 s77, s77, s28
    s_cmp_lt_u32 s77, 144
    s_cselect_b32 s77, s77, 255
    s_mul_i32 s46, s29, 3
    s_add_u32 s46, s46, s28
    s_add_u32 s46, s46, 91
    s_cmp_ge_u32 s29, 16
    s_cselect_b32 s46, s46, 255
    s_cmp_ge_u32 s28, 5
    s_cselect_b32 s77, s46, s77
    s_and_b32 s45, s77, 1
    s_mul_i32 s45, s45, 320
    s_lshl_b32 s46, s30, 6
    s_add_u32 s45, s45, s46
    s_lshl_b32 s46, s45, 1
    v_lshl_add_u32 v5, v7, 4, s46
    v_mul_u32_u24 v3, 20, v1
    v_mul_u32_u24 v6, 98304, v7
    v_lshl_add_u32 v6, v8, 4, v6
    s_lshr_b32 s46, s77, 1
    s_lshl_b32 s46, s46, 7
    s_mul_i32 s45, s45, 12288
    s_add_u32 s45, s45, s46
    v_mul_u32_u24 v2, 384, v7
    v_lshl_add_u32 v2, v8, 4, v2
    s_mul_i32 s46, s28, 12582912
    s_lshl_b32 s37, s29, 2
    s_add_u32 s37, s37, s30
    s_mul_i32 s37, s37, 6144
    s_mov_b32 s36, s37
    s_mov_b32 s34, 314572800
    s_mov_b32 s35, 0x20000
    s_lshl_b32 s53, s28, 5
    s_add_u32 s53, s53, s29
    s_add_u32 s53, s53, 20
    s_cmp_ge_u32 s53, 160
    s_cselect_b32 s48, 160, 0
    s_sub_u32 s53, s53, s48
    s_cmp_lt_u32 s29, 16
    s_cselect_b32 s69, 2, 0
    s_cmp_lt_u32 s29, 8
    s_cselect_b32 s48, 5, 1
    s_sub_u32 s71, s28, 5
    s_lshl_b32 s71, s71, 4
    s_add_u32 s71, s71, s29
    s_mul_i32 s49, s29, 5
    s_add_u32 s49, s49, s28
    s_cmp_lt_u32 s28, 5
    s_cselect_b32 s69, s48, s69
    s_cselect_b32 s71, s49, s71
    s_mul_i32 s64, s53, 3277
    s_lshr_b32 s64, s64, 16
    s_mul_i32 s48, s64, 20
    s_sub_u32 s65, s53, s48
    s_cmp_ge_u32 s65, 10
    s_cselect_b32 s67, 1, 0
    s_cselect_b32 s48, 10, 0
    s_sub_u32 s65, s65, s48
    s_lshl_b32 s53, s67, 3
    s_add_u32 s53, s53, s64
    s_mul_i32 s53, s53, 10
    s_add_u32 s53, s53, s65
    s_lshl_b32 s53, s53, 8
    s_add_u32 s53, s53, 49152
    v_mov_b32 v10, 0
    s_mul_i32 s47, s30, 768
    v_add_u32 v11, s47, v4
    s_cmp_eq_u32 s30, 5
    s_cbranch_scc1 L_aux
    s_cmp_ge_u32 s77, 192
    s_cbranch_scc1 L_noq
    s_waitcnt lgkmcnt(0)
    s_add_u32 s48, s10, s45
    s_addc_u32 s49, s11, 0
    global_load_dwordx4 v[188:191], v3, s[4:5]
    global_load_dword v192, v3, s[4:5] offset:16
    global_load_dwordx4 v[212:215], v5, s[4:5]
    global_load_dwordx4 v[156:159], v6, s[48:49] nt
    s_add_u32 s48, s48, 12288
    s_addc_u32 s49, s49, 0
    global_load_dwordx4 v[160:163], v6, s[48:49] nt
    s_add_u32 s48, s48, 12288
    s_addc_u32 s49, s49, 0
    global_load_dwordx4 v[164:167], v6, s[48:49] nt
    s_add_u32 s48, s48, 12288
    s_addc_u32 s49, s49, 0
    global_load_dwordx4 v[168:171], v6, s[48:49] nt
    s_add_u32 s48, s48, 12288
    s_addc_u32 s49, s49, 0
    global_load_dwordx4 v[172:175], v6, s[48:49] nt
    s_add_u32 s48, s48, 12288
    s_addc_u32 s49, s49, 0
    global_load_dwordx4 v[176:179], v6, s[48:49] nt
    s_add_u32 s48, s48, 12288
    s_addc_u32 s49, s49, 0
    global_load_dwordx4 v[180:183], v6, s[48:49] nt
    s_add_u32 s48, s48, 12288
    s_addc_u32 s49, s49, 0
    global_load_dwordx4 v[184:187], v6, s[48:49] nt
    s_add_u32 s32, s6, s46
    s_addc_u32 s33, s7, 0
    s_add_u32 s38, s8, s46
    s_addc_u32 s39, s9, 0
    s_barrier
    s_cmp_lg_u32 s30, 4
    s_cbranch_scc1 L_p1
    s_load_dword s31, s[26:27], 0
L_p1:
    v_mov_b32 v36, 0
    v_mov_b32 v37, 0
    v_mov_b32 v38, 0
    v_mov_b32 v39, 0
    v_mov_b32 v40, 0
    v_mov_b32 v41, 0
    v_mov_b32 v42, 0
    v_mov_b32 v43, 0
    v_lshl_add_u32 v3, v8, 3, v7
    s_lshl_b32 s46, s30, 8
    v_lshl_add_u32 v3, v3, 2, s46
    v_mov_b32 v9, 1
    s_waitcnt vmcnt(8)
    v_lshlrev_b32 v194, 16, v212
    v_and_b32 v195, 0xffff0000, v212
    v_lshlrev_b32 v196, 16, v213
    v_and_b32 v197, 0xffff0000, v213
    v_lshlrev_b32 v198, 16, v214
    v_and_b32 v199, 0xffff0000, v214
    v_lshlrev_b32 v200, 16, v215
    v_and_b32 v201, 0xffff0000, v215
    v_lshlrev_b32 v202, 16, v188
    v_and_b32 v203, 0xffff0000, v188
    v_lshlrev_b32 v204, 16, v189
    v_and_b32 v205, 0xffff0000, v189
    v_lshlrev_b32 v206, 16, v190
    v_and_b32 v207, 0xffff0000, v190
    v_lshlrev_b32 v208, 16, v191
    v_and_b32 v209, 0xffff0000, v191
    v_lshlrev_b32 v210, 16, v192
    v_and_b32 v211, 0xffff0000, v192
    v_pk_add_f32 v[12:13], v[202:203], v[204:205]
    v_pk_add_f32 v[14:15], v[206:207], v[208:209]
    v_pk_add_f32 v[12:13], v[12:13], v[210:211]
    v_pk_add_f32 v[12:13], v[12:13], v[14:15]
    v_add_f32 v12, v12, v13
    s_nop 1
    v_add_f32_dpp v12, v12, v12 quad_perm:[1,0,3,2] row_mask:0xf bank_mask:0xf
    s_nop 1
    v_add_f32_dpp v12, v12, v12 quad_perm:[2,3,0,1] row_mask:0xf bank_mask:0xf
    s_nop 1
    v_add_f32_dpp v12, v12, v12 row_half_mirror row_mask:0xf bank_mask:0xf
    s_nop 1
    v_add_f32_dpp v12, v12, v12 row_mirror row_mask:0xf bank_mask:0xf
    s_nop 1
    v_add_f32_dpp v12, v12, v12 row_bcast:15 row_mask:0xa bank_mask:0xf
    s_nop 1
    v_add_f32_dpp v12, v12, v12 row_bcast:31 row_mask:0xc bank_mask:0xf
    s_nop 0
    v_readlane_b32 s40, v12, 63
    v_mov_b32 v13, 0x3acccccd
    s_nop 0
    v_mul_f32 v14, s40, v13
    v_sub_f32 v202, v202, v14
    v_sub_f32 v203, v203, v14
    v_sub_f32 v204, v204, v14
    v_sub_f32 v205, v205, v14
    v_sub_f32 v206, v206, v14
    v_sub_f32 v207, v207, v14
    v_sub_f32 v208, v208, v14
    v_sub_f32 v209, v209, v14
    v_sub_f32 v210, v210, v14
    v_sub_f32 v211, v211, v14
    v_mul_f32 v12, v202, v202
    v_mul_f32 v17, v203, v203
    v_fmac_f32 v12, v204, v204
    v_fmac_f32 v17, v205, v205
    v_fmac_f32 v12, v206, v206
    v_fmac_f32 v17, v207, v207
    v_fmac_f32 v12, v208, v208
    v_fmac_f32 v17, v209, v209
    v_fmac_f32 v12, v210, v210
    v_fmac_f32 v17, v211, v211
    v_add_f32 v12, v12, v17
    v_cvt_pk_bf16_f32 v14, 0, v14
    s_nop 0
    v_add_f32_dpp v12, v12, v12 quad_perm:[1,0,3,2] row_mask:0xf bank_mask:0xf
    s_nop 1
    v_add_f32_dpp v12, v12, v12 quad_perm:[2,3,0,1] row_mask:0xf bank_mask:0xf
    s_nop 1
    v_add_f32_dpp v12, v12, v12 row_half_mirror row_mask:0xf bank_mask:0xf
    s_nop 1
    v_add_f32_dpp v12, v12, v12 row_mirror row_mask:0xf bank_mask:0xf
    s_nop 1
    v_add_f32_dpp v12, v12, v12 row_bcast:15 row_mask:0xa bank_mask:0xf
    s_nop 1
    v_add_f32_dpp v12, v12, v12 row_bcast:31 row_mask:0xc bank_mask:0xf
    s_nop 0
    v_readlane_b32 s41, v12, 63
    v_sub_f32 v194, v194, v14
    v_sub_f32 v195, v195, v14
    v_sub_f32 v196, v196, v14
    v_sub_f32 v197, v197, v14
    v_sub_f32 v198, v198, v14
    v_sub_f32 v199, v199, v14
    v_sub_f32 v200, v200, v14
    v_sub_f32 v201, v201, v14
    v_mul_f32 v15, s41, v13
    v_cvt_pk_bf16_f32 v15, 0, v15
    v_add_f32 v15, 0x3727c5ac, v15
    v_cvt_pk_bf16_f32 v15, 0, v15
    v_sqrt_f32 v15, v15
    v_cvt_pk_bf16_f32 v194, 0, v194
    v_cvt_pk_bf16_f32 v195, 0, v195
    v_cvt_pk_bf16_f32 v196, 0, v196
    v_cvt_pk_bf16_f32 v197, 0, v197
    v_cvt_pk_bf16_f32 v198, 0, v198
    v_cvt_pk_bf16_f32 v199, 0, v199
    v_cvt_pk_bf16_f32 v200, 0, v200
    v_cvt_pk_bf16_f32 v201, 0, v201
    v_cvt_pk_bf16_f32 v15, 0, v15
    v_rcp_f32 v16, v15
    s_nop 0
    v_mul_f32 v44, v194, v16
    v_mul_f32 v45, v195, v16
    v_mul_f32 v46, v196, v16
    v_mul_f32 v47, v197, v16
    v_mul_f32 v48, v198, v16
    v_mul_f32 v49, v199, v16
    v_mul_f32 v50, v200, v16
    v_mul_f32 v51, v201, v16
    v_fma_f32 v194, -v44, v15, v194
    v_fma_f32 v195, -v45, v15, v195
    v_fma_f32 v196, -v46, v15, v196
    v_fma_f32 v197, -v47, v15, v197
    v_fma_f32 v198, -v48, v15, v198
    v_fma_f32 v199, -v49, v15, v199
    v_fma_f32 v200, -v50, v15, v200
    v_fma_f32 v201, -v51, v15, v201
    v_fma_f32 v194, v194, v16, v44
    v_fma_f32 v195, v195, v16, v45
    v_fma_f32 v196, v196, v16, v46
    v_fma_f32 v197, v197, v16, v47
    v_fma_f32 v198, v198, v16, v48
    v_fma_f32 v199, v199, v16, v49
    v_fma_f32 v200, v200, v16, v50
    v_fma_f32 v201, v201, v16, v51
    v_cvt_pk_bf16_f32 v44, v194, 0
    v_cvt_pk_bf16_f32 v52, 0, v194
    v_cvt_pk_bf16_f32 v45, v195, 0
    v_cvt_pk_bf16_f32 v53, 0, v195
    v_cvt_pk_bf16_f32 v46, v196, 0
    v_cvt_pk_bf16_f32 v54, 0, v196
    v_cvt_pk_bf16_f32 v47, v197, 0
    v_cvt_pk_bf16_f32 v55, 0, v197
    v_cvt_pk_bf16_f32 v48, v198, 0
    v_cvt_pk_bf16_f32 v56, 0, v198
    v_cvt_pk_bf16_f32 v49, v199, 0
    v_cvt_pk_bf16_f32 v57, 0, v199
    v_cvt_pk_bf16_f32 v50, v200, 0
    v_cvt_pk_bf16_f32 v58, 0, v200
    v_cvt_pk_bf16_f32 v51, v201, 0
    v_cvt_pk_bf16_f32 v59, 0, v201
    s_waitcnt vmcnt(7)
    v_dot2c_f32_bf16 v36, v156, v44
    v_dot2c_f32_bf16 v37, v156, v52
    v_dot2c_f32_bf16 v38, v157, v44
    v_dot2c_f32_bf16 v39, v157, v52
    v_dot2c_f32_bf16 v40, v158, v44
    v_dot2c_f32_bf16 v41, v158, v52
    v_dot2c_f32_bf16 v42, v159, v44
    v_dot2c_f32_bf16 v43, v159, v52
    s_waitcnt vmcnt(6)
    v_dot2c_f32_bf16 v36, v160, v45
    v_dot2c_f32_bf16 v37, v160, v53
    v_dot2c_f32_bf16 v38, v161, v45
    v_dot2c_f32_bf16 v39, v161, v53
    v_dot2c_f32_bf16 v40, v162, v45
    v_dot2c_f32_bf16 v41, v162, v53
    v_dot2c_f32_bf16 v42, v163, v45
    v_dot2c_f32_bf16 v43, v163, v53
    s_waitcnt vmcnt(5)
    v_dot2c_f32_bf16 v36, v164, v46
    v_dot2c_f32_bf16 v37, v164, v54
    v_dot2c_f32_bf16 v38, v165, v46
    v_dot2c_f32_bf16 v39, v165, v54
    v_dot2c_f32_bf16 v40, v166, v46
    v_dot2c_f32_bf16 v41, v166, v54
    v_dot2c_f32_bf16 v42, v167, v46
    v_dot2c_f32_bf16 v43, v167, v54
    s_waitcnt vmcnt(4)
    v_dot2c_f32_bf16 v36, v168, v47
    v_dot2c_f32_bf16 v37, v168, v55
    v_dot2c_f32_bf16 v38, v169, v47
    v_dot2c_f32_bf16 v39, v169, v55
    v_dot2c_f32_bf16 v40, v170, v47
    v_dot2c_f32_bf16 v41, v170, v55
    v_dot2c_f32_bf16 v42, v171, v47
    v_dot2c_f32_bf16 v43, v171, v55
    s_waitcnt vmcnt(3)
    v_dot2c_f32_bf16 v36, v172, v48
    v_dot2c_f32_bf16 v37, v172, v56
    v_dot2c_f32_bf16 v38, v173, v48
    v_dot2c_f32_bf16 v39, v173, v56
    v_dot2c_f32_bf16 v40, v174, v48
    v_dot2c_f32_bf16 v41, v174, v56
    v_dot2c_f32_bf16 v42, v175, v48
    v_dot2c_f32_bf16 v43, v175, v56
    s_waitcnt vmcnt(2)
    v_dot2c_f32_bf16 v36, v176, v49
    v_dot2c_f32_bf16 v37, v176, v57
    v_dot2c_f32_bf16 v38, v177, v49
    v_dot2c_f32_bf16 v39, v177, v57
    v_dot2c_f32_bf16 v40, v178, v49
    v_dot2c_f32_bf16 v41, v178, v57
    v_dot2c_f32_bf16 v42, v179, v49
    v_dot2c_f32_bf16 v43, v179, v57
    s_waitcnt vmcnt(1)
    v_dot2c_f32_bf16 v36, v180, v50
    v_dot2c_f32_bf16 v37, v180, v58
    v_dot2c_f32_bf16 v38, v181, v50
    v_dot2c_f32_bf16 v39, v181, v58
    v_dot2c_f32_bf16 v40, v182, v50
    v_dot2c_f32_bf16 v41, v182, v58
    v_dot2c_f32_bf16 v42, v183, v50
    v_dot2c_f32_bf16 v43, v183, v58
    s_waitcnt vmcnt(0)
    v_dot2c_f32_bf16 v36, v184, v51
    v_dot2c_f32_bf16 v37, v184, v59
    v_dot2c_f32_bf16 v38, v185, v51
    v_dot2c_f32_bf16 v39, v185, v59
    v_dot2c_f32_bf16 v40, v186, v51
    v_dot2c_f32_bf16 v41, v186, v59
    v_dot2c_f32_bf16 v42, v187, v51
    v_dot2c_f32_bf16 v43, v187, v59
    v_permlane32_swap_b32 v36, v40
    v_permlane32_swap_b32 v37, v41
    v_permlane32_swap_b32 v38, v42
    v_permlane32_swap_b32 v39, v43
    v_pk_add_f32 v[36:37], v[36:37], v[40:41]
    v_pk_add_f32 v[38:39], v[38:39], v[42:43]
    s_nop 1
    v_permlane16_swap_b32 v36, v38
    v_permlane16_swap_b32 v37, v39
    v_pk_add_f32 v[36:37], v[36:37], v[38:39]
    s_nop 1
    v_add_f32_dpp v38, v36, v36 row_ror:8 row_mask:0xf bank_mask:0x3
    s_nop 1
    v_add_f32_dpp v38, v37, v37 row_ror:8 row_mask:0xf bank_mask:0xc
    ds_write_b32 v3, v38 offset:18432
    s_mov_b64 exec, 1
    ds_add_u32 v10, v9 offset:24
    s_mov_b64 exec, -1
    s_cmp_eq_u32 s30, 4
    s_cbranch_scc1 L_helper
L_stream:
    s_lshl_b32 s46, s30, 12
    v_lshl_add_u32 v3, v7, 4, s46
    v_lshlrev_b32 v6, 4, v8
    s_lshl_b32 s46, s30, 2
    v_mov_b32 v5, s46
    s_mov_b32 s51, 3
    v_and_b32 v249, 3, v1
    v_lshlrev_b32 v249, 2, v249
L_go:
    ds_read_b32 v12, v10 offset:60
    s_waitcnt lgkmcnt(0)
    v_readfirstlane_b32 s46, v12
    s_nop 0
    s_cmp_lg_u32 s46, 0
    s_cbranch_scc1 L_go_ok
    s_sub_u32 s44, s44, 1
    s_cmp_eq_u32 s44, 0
    s_cbranch_scc1 L_exit
    s_sleep 1
    s_branch L_go
L_go_ok:
    buffer_load_dwordx4 v[108:111], v2, s[32:35], s36 offen offset:0 nt
    buffer_load_dwordx4 v[112:115], v2, s[32:35], s36 offen offset:128 nt
    buffer_load_dwordx4 v[116:119], v2, s[32:35], s36 offen offset:256 nt
    s_add_u32 s36, s36, 3072
    s_waitcnt vmcnt(5)
    buffer_load_dwordx4 v[120:123], v2, s[32:35], s36 offen offset:0 nt
    s_waitcnt vmcnt(5)
    buffer_load_dwordx4 v[124:127], v2, s[32:35], s36 offen offset:128 nt
    s_waitcnt vmcnt(5)
    buffer_load_dwordx4 v[128:131], v2, s[32:35], s36 offen offset:256 nt
    s_add_u32 s36, s36, 783360
    s_waitcnt vmcnt(5)
    buffer_load_dwordx4 v[132:135], v2, s[32:35], s36 offen offset:0 nt
    s_waitcnt vmcnt(5)
    buffer_load_dwordx4 v[136:139], v2, s[32:35], s36 offen offset:128 nt
    s_waitcnt vmcnt(5)
    buffer_load_dwordx4 v[140:143], v2, s[32:35], s36 offen offset:256 nt
    s_add_u32 s36, s36, 3072
    s_waitcnt vmcnt(5)
    buffer_load_dwordx4 v[144:147], v2, s[32:35], s36 offen offset:0 nt
    s_waitcnt vmcnt(5)
    buffer_load_dwordx4 v[148:151], v2, s[32:35], s36 offen offset:128 nt
    s_waitcnt vmcnt(5)
    buffer_load_dwordx4 v[152:155], v2, s[32:35], s36 offen offset:256 nt
    s_add_u32 s36, s36, 783360
    s_waitcnt vmcnt(5)
    buffer_load_dwordx4 v[156:159], v2, s[32:35], s36 offen offset:0 nt
    s_waitcnt vmcnt(5)
    buffer_load_dwordx4 v[160:163], v2, s[32:35], s36 offen offset:128 nt
    s_waitcnt vmcnt(5)
    buffer_load_dwordx4 v[164:167], v2, s[32:35], s36 offen offset:256 nt
    s_add_u32 s36, s36, 3072
    s_waitcnt vmcnt(5)
    buffer_load_dwordx4 v[168:171], v2, s[32:35], s36 offen offset:0 nt
    s_waitcnt vmcnt(5)
    buffer_load_dwordx4 v[172:175], v2, s[32:35], s36 offen offset:128 nt
    s_waitcnt vmcnt(5)
    buffer_load_dwordx4 v[176:179], v2, s[32:35], s36 offen offset:256 nt
    s_add_u32 s36, s36, 783360
    s_waitcnt vmcnt(5)
    buffer_load_dwordx4 v[180:183], v2, s[32:35], s36 offen offset:0 nt
    s_waitcnt vmcnt(5)
    buffer_load_dwordx4 v[184:187], v2, s[32:35], s36 offen offset:128 nt
    s_waitcnt vmcnt(5)
    buffer_load_dwordx4 v[188:191], v2, s[32:35], s36 offen offset:256 nt
    s_add_u32 s36, s36, 3072
    s_waitcnt vmcnt(5)
    buffer_load_dwordx4 v[192:195], v2, s[32:35], s36 offen offset:0 nt
    s_waitcnt vmcnt(5)
    buffer_load_dwordx4 v[196:199], v2, s[32:35], s36 offen offset:128 nt
    s_waitcnt vmcnt(5)
    buffer_load_dwordx4 v[200:203], v2, s[32:35], s36 offen offset:256 nt
    s_add_u32 s36, s36, 783360
    s_waitcnt vmcnt(5)
    buffer_load_dwordx4 v[60:63], v2, s[32:35], s36 offen offset:0 nt
    s_waitcnt vmcnt(5)
    buffer_load_dwordx4 v[64:67], v2, s[32:35], s36 offen offset:128 nt
    s_waitcnt vmcnt(5)
    buffer_load_dwordx4 v[68:71], v2, s[32:35], s36 offen offset:256 nt
    s_add_u32 s36, s36, 3072
    v_mov_b32 v9, 1
    ds_write_b32 v10, v9 offset:20
    s_waitcnt vmcnt(5)
    buffer_load_dwordx4 v[72:75], v2, s[32:35], s36 offen offset:0 nt
    s_waitcnt vmcnt(5)
    buffer_load_dwordx4 v[76:79], v2, s[32:35], s36 offen offset:128 nt
    s_waitcnt vmcnt(5)
    buffer_load_dwordx4 v[80:83], v2, s[32:35], s36 offen offset:256 nt
    s_add_u32 s36, s36, 783360
    s_waitcnt vmcnt(5)
    buffer_load_dwordx4 v[84:87], v2, s[32:35], s36 offen offset:0 nt
    s_waitcnt vmcnt(5)
    buffer_load_dwordx4 v[88:91], v2, s[32:35], s36 offen offset:128 nt
    s_waitcnt vmcnt(5)
    buffer_load_dwordx4 v[92:95], v2, s[32:35], s36 offen offset:256 nt
    s_add_u32 s36, s36, 3072
    s_waitcnt vmcnt(5)
    buffer_load_dwordx4 v[96:99], v2, s[32:35], s36 offen offset:0 nt
    s_waitcnt vmcnt(5)
    buffer_load_dwordx4 v[100:103], v2, s[32:35], s36 offen offset:128 nt
    s_waitcnt vmcnt(5)
    buffer_load_dwordx4 v[104:107], v2, s[32:35], s36 offen offset:256 nt
    s_add_u32 s36, s36, 783360
L_fl2:
    s_barrier
    ds_read_b128 v[12:15], v6 offset:512
    ds_read_b128 v[16:19], v6 offset:640
    ds_read_b128 v[20:23], v6 offset:768
    s_waitcnt lgkmcnt(0)
    s_waitcnt vmcnt(9)
    v_dot2_f32_bf16 v32, v60, v12, 0
    v_dot2_f32_bf16 v32, v61, v13, v32
    v_dot2_f32_bf16 v32, v62, v14, v32
    v_dot2_f32_bf16 v32, v63, v15, v32
    v_dot2_f32_bf16 v32, v64, v16, v32
    v_dot2_f32_bf16 v32, v65, v17, v32
    v_dot2_f32_bf16 v32, v66, v18, v32
    v_dot2_f32_bf16 v32, v67, v19, v32
    v_dot2_f32_bf16 v32, v68, v20, v32
    v_dot2_f32_bf16 v32, v69, v21, v32
    v_dot2_f32_bf16 v32, v70, v22, v32
    v_dot2_f32_bf16 v32, v71, v23, v32
    buffer_load_dwordx4 v[60:63], v2, s[32:35], s36 offen offset:0 nt
    buffer_load_dwordx4 v[64:67], v2, s[32:35], s36 offen offset:128 nt
    buffer_load_dwordx4 v[68:71], v2, s[32:35], s36 offen offset:256 nt
    s_add_u32 s36, s36, 3072
    s_waitcnt vmcnt(9)
    v_dot2_f32_bf16 v33, v72, v12, 0
    v_dot2_f32_bf16 v33, v73, v13, v33
    v_dot2_f32_bf16 v33, v74, v14, v33
    v_dot2_f32_bf16 v33, v75, v15, v33
    v_dot2_f32_bf16 v33, v76, v16, v33
    v_dot2_f32_bf16 v33, v77, v17, v33
    v_dot2_f32_bf16 v33, v78, v18, v33
    v_dot2_f32_bf16 v33, v79, v19, v33
    v_dot2_f32_bf16 v33, v80, v20, v33
    v_dot2_f32_bf16 v33, v81, v21, v33
    v_dot2_f32_bf16 v33, v82, v22, v33
    v_dot2_f32_bf16 v33, v83, v23, v33
    buffer_load_dwordx4 v[72:75], v2, s[32:35], s36 offen offset:0 nt
    buffer_load_dwordx4 v[76:79], v2, s[32:35], s36 offen offset:128 nt
    buffer_load_dwordx4 v[80:83], v2, s[32:35], s36 offen offset:256 nt
    s_add_u32 s36, s36, 783360
    s_waitcnt vmcnt(9)
    v_dot2_f32_bf16 v34, v84, v12, 0
    v_dot2_f32_bf16 v34, v85, v13, v34
    v_dot2_f32_bf16 v34, v86, v14, v34
    v_dot2_f32_bf16 v34, v87, v15, v34
    v_dot2_f32_bf16 v34, v88, v16, v34
    v_dot2_f32_bf16 v34, v89, v17, v34
    v_dot2_f32_bf16 v34, v90, v18, v34
    v_dot2_f32_bf16 v34, v91, v19, v34
    v_dot2_f32_bf16 v34, v92, v20, v34
    v_dot2_f32_bf16 v34, v93, v21, v34
    v_dot2_f32_bf16 v34, v94, v22, v34
    v_dot2_f32_bf16 v34, v95, v23, v34
    buffer_load_dwordx4 v[84:87], v2, s[32:35], s36 offen offset:0 nt
    buffer_load_dwordx4 v[88:91], v2, s[32:35], s36 offen offset:128 nt
    buffer_load_dwordx4 v[92:95], v2, s[32:35], s36 offen offset:256 nt
    s_add_u32 s36, s36, 3072
    v_dot2_f32_bf16 v24, v108, v12, 0
    v_dot2_f32_bf16 v24, v109, v13, v24
    v_dot2_f32_bf16 v24, v110, v14, v24
    v_dot2_f32_bf16 v24, v111, v15, v24
    v_dot2_f32_bf16 v24, v112, v16, v24
    v_dot2_f32_bf16 v24, v113, v17, v24
    v_dot2_f32_bf16 v24, v114, v18, v24
    v_dot2_f32_bf16 v24, v115, v19, v24
    v_dot2_f32_bf16 v24, v116, v20, v24
    v_dot2_f32_bf16 v24, v117, v21, v24
    v_dot2_f32_bf16 v24, v118, v22, v24
    v_dot2_f32_bf16 v24, v119, v23, v24
    v_dot2_f32_bf16 v25, v120, v12, 0
    v_dot2_f32_bf16 v25, v121, v13, v25
    v_dot2_f32_bf16 v25, v122, v14, v25
    v_dot2_f32_bf16 v25, v123, v15, v25
    v_dot2_f32_bf16 v25, v124, v16, v25
    v_dot2_f32_bf16 v25, v125, v17, v25
    v_dot2_f32_bf16 v25, v126, v18, v25
    v_dot2_f32_bf16 v25, v127, v19, v25
    v_dot2_f32_bf16 v25, v128, v20, v25
    v_dot2_f32_bf16 v25, v129, v21, v25
    v_dot2_f32_bf16 v25, v130, v22, v25
    v_dot2_f32_bf16 v25, v131, v23, v25
    v_dot2_f32_bf16 v26, v132, v12, 0
    v_dot2_f32_bf16 v26, v133, v13, v26
    v_dot2_f32_bf16 v26, v134, v14, v26
    v_dot2_f32_bf16 v26, v135, v15, v26
    v_dot2_f32_bf16 v26, v136, v16, v26
    v_dot2_f32_bf16 v26, v137, v17, v26
    v_dot2_f32_bf16 v26, v138, v18, v26
    v_dot2_f32_bf16 v26, v139, v19, v26
    v_dot2_f32_bf16 v26, v140, v20, v26
    v_dot2_f32_bf16 v26, v141, v21, v26
    v_dot2_f32_bf16 v26, v142, v22, v26
    v_dot2_f32_bf16 v26, v143, v23, v26
    v_dot2_f32_bf16 v27, v144, v12, 0
    v_dot2_f32_bf16 v27, v145, v13, v27
    v_dot2_f32_bf16 v27, v146, v14, v27
    v_dot2_f32_bf16 v27, v147, v15, v27
    v_dot2_f32_bf16 v27, v148, v16, v27
    v_dot2_f32_bf16 v27, v149, v17, v27
    v_dot2_f32_bf16 v27, v150, v18, v27
    v_dot2_f32_bf16 v27, v151, v19, v27
    v_dot2_f32_bf16 v27, v152, v20, v27
    v_dot2_f32_bf16 v27, v153, v21, v27
    v_dot2_f32_bf16 v27, v154, v22, v27
    v_dot2_f32_bf16 v27, v155, v23, v27
    v_dot2_f32_bf16 v28, v156, v12, 0
    v_dot2_f32_bf16 v28, v157, v13, v28
    v_dot2_f32_bf16 v28, v158, v14, v28
    v_dot2_f32_bf16 v28, v159, v15, v28
    v_dot2_f32_bf16 v28, v160, v16, v28
    v_dot2_f32_bf16 v28, v161, v17, v28
    v_dot2_f32_bf16 v28, v162, v18, v28
    v_dot2_f32_bf16 v28, v163, v19, v28
    v_dot2_f32_bf16 v28, v164, v20, v28
    v_dot2_f32_bf16 v28, v165, v21, v28
    v_dot2_f32_bf16 v28, v166, v22, v28
    v_dot2_f32_bf16 v28, v167, v23, v28
    v_dot2_f32_bf16 v29, v168, v12, 0
    v_dot2_f32_bf16 v29, v169, v13, v29
    v_dot2_f32_bf16 v29, v170, v14, v29
    v_dot2_f32_bf16 v29, v171, v15, v29
    v_dot2_f32_bf16 v29, v172, v16, v29
    v_dot2_f32_bf16 v29, v173, v17, v29
    v_dot2_f32_bf16 v29, v174, v18, v29
    v_dot2_f32_bf16 v29, v175, v19, v29
    v_dot2_f32_bf16 v29, v176, v20, v29
    v_dot2_f32_bf16 v29, v177, v21, v29
    v_dot2_f32_bf16 v29, v178, v22, v29
    v_dot2_f32_bf16 v29, v179, v23, v29
    v_dot2_f32_bf16 v30, v180, v12, 0
    v_dot2_f32_bf16 v30, v181, v13, v30
    v_dot2_f32_bf16 v30, v182, v14, v30
    v_dot2_f32_bf16 v30, v183, v15, v30
    v_dot2_f32_bf16 v30, v184, v16, v30
    v_dot2_f32_bf16 v30, v185, v17, v30
    v_dot2_f32_bf16 v30, v186, v18, v30
    v_dot2_f32_bf16 v30, v187, v19, v30
    v_dot2_f32_bf16 v30, v188, v20, v30
    v_dot2_f32_bf16 v30, v189, v21, v30
    v_dot2_f32_bf16 v30, v190, v22, v30
    v_dot2_f32_bf16 v30, v191, v23, v30
    v_dot2_f32_bf16 v31, v192, v12, 0
    v_dot2_f32_bf16 v31, v193, v13, v31
    v_dot2_f32_bf16 v31, v194, v14, v31
    v_dot2_f32_bf16 v31, v195, v15, v31
    v_dot2_f32_bf16 v31, v196, v16, v31
    v_dot2_f32_bf16 v31, v197, v17, v31
    v_dot2_f32_bf16 v31, v198, v18, v31
    v_dot2_f32_bf16 v31, v199, v19, v31
    v_dot2_f32_bf16 v31, v200, v20, v31
    v_dot2_f32_bf16 v31, v201, v21, v31
    v_dot2_f32_bf16 v31, v202, v22, v31
    v_dot2_f32_bf16 v31, v203, v23, v31
    s_waitcnt vmcnt(9)
    v_dot2_f32_bf16 v35, v96, v12, 0
    v_dot2_f32_bf16 v35, v97, v13, v35
    v_dot2_f32_bf16 v35, v98, v14, v35
    v_dot2_f32_bf16 v35, v99, v15, v35
    v_dot2_f32_bf16 v35, v100, v16, v35
    v_dot2_f32_bf16 v35, v101, v17, v35
    v_dot2_f32_bf16 v35, v102, v18, v35
    v_dot2_f32_bf16 v35, v103, v19, v35
    v_dot2_f32_bf16 v35, v104, v20, v35
    v_dot2_f32_bf16 v35, v105, v21, v35
    v_dot2_f32_bf16 v35, v106, v22, v35
    v_dot2_f32_bf16 v35, v107, v23, v35
    v_add_f32_dpp v24, v24, v24 quad_perm:[1,0,3,2] row_mask:0xf bank_mask:0xf
    v_add_f32_dpp v25, v25, v25 quad_perm:[1,0,3,2] row_mask:0xf bank_mask:0xf
    v_add_f32_dpp v26, v26, v26 quad_perm:[1,0,3,2] row_mask:0xf bank_mask:0xf
    v_add_f32_dpp v27, v27, v27 quad_perm:[1,0,3,2] row_mask:0xf bank_mask:0xf
    v_add_f32_dpp v28, v28, v28 quad_perm:[1,0,3,2] row_mask:0xf bank_mask:0xf
    v_add_f32_dpp v29, v29, v29 quad_perm:[1,0,3,2] row_mask:0xf bank_mask:0xf
    v_add_f32_dpp v30, v30, v30 quad_perm:[1,0,3,2] row_mask:0xf bank_mask:0xf
    v_add_f32_dpp v31, v31, v31 quad_perm:[1,0,3,2] row_mask:0xf bank_mask:0xf
    v_add_f32_dpp v32, v32, v32 quad_perm:[1,0,3,2] row_mask:0xf bank_mask:0xf
    v_add_f32_dpp v33, v33, v33 quad_perm:[1,0,3,2] row_mask:0xf bank_mask:0xf
    v_add_f32_dpp v34, v34, v34 quad_perm:[1,0,3,2] row_mask:0xf bank_mask:0xf
    v_add_f32_dpp v35, v35, v35 quad_perm:[1,0,3,2] row_mask:0xf bank_mask:0xf
    v_add_f32_dpp v24, v24, v24 quad_perm:[2,3,0,1] row_mask:0xf bank_mask:0xf
    v_add_f32_dpp v25, v25, v25 quad_perm:[2,3,0,1] row_mask:0xf bank_mask:0xf
    v_add_f32_dpp v26, v26, v26 quad_perm:[2,3,0,1] row_mask:0xf bank_mask:0xf
    v_add_f32_dpp v27, v27, v27 quad_perm:[2,3,0,1] row_mask:0xf bank_mask:0xf
    v_add_f32_dpp v28, v28, v28 quad_perm:[2,3,0,1] row_mask:0xf bank_mask:0xf
    v_add_f32_dpp v29, v29, v29 quad_perm:[2,3,0,1] row_mask:0xf bank_mask:0xf
    v_add_f32_dpp v30, v30, v30 quad_perm:[2,3,0,1] row_mask:0xf bank_mask:0xf
    v_add_f32_dpp v31, v31, v31 quad_perm:[2,3,0,1] row_mask:0xf bank_mask:0xf
    v_add_f32_dpp v32, v32, v32 quad_perm:[2,3,0,1] row_mask:0xf bank_mask:0xf
    v_add_f32_dpp v33, v33, v33 quad_perm:[2,3,0,1] row_mask:0xf bank_mask:0xf
    v_add_f32_dpp v34, v34, v34 quad_perm:[2,3,0,1] row_mask:0xf bank_mask:0xf
    v_add_f32_dpp v35, v35, v35 quad_perm:[2,3,0,1] row_mask:0xf bank_mask:0xf
    v_add_f32_dpp v24, v24, v24 row_half_mirror row_mask:0xf bank_mask:0xf
    v_add_f32_dpp v25, v25, v25 row_half_mirror row_mask:0xf bank_mask:0xf
    v_add_f32_dpp v26, v26, v26 row_half_mirror row_mask:0xf bank_mask:0xf
    v_add_f32_dpp v27, v27, v27 row_half_mirror row_mask:0xf bank_mask:0xf
    v_add_f32_dpp v28, v28, v28 row_half_mirror row_mask:0xf bank_mask:0xf
    v_add_f32_dpp v29, v29, v29 row_half_mirror row_mask:0xf bank_mask:0xf
    v_add_f32_dpp v30, v30, v30 row_half_mirror row_mask:0xf bank_mask:0xf
    v_add_f32_dpp v31, v31, v31 row_half_mirror row_mask:0xf bank_mask:0xf
    v_add_f32_dpp v32, v32, v32 row_half_mirror row_mask:0xf bank_mask:0xf
    v_add_f32_dpp v33, v33, v33 row_half_mirror row_mask:0xf bank_mask:0xf
    v_add_f32_dpp v34, v34, v34 row_half_mirror row_mask:0xf bank_mask:0xf
    v_add_f32_dpp v35, v35, v35 row_half_mirror row_mask:0xf bank_mask:0xf
    s_mov_b32 exec_lo, 0x01010101
    s_mov_b32 exec_hi, 0x01010101
    ds_write_b128 v3, v[24:27] offset:2048
    ds_write_b128 v3, v[28:31] offset:2176
    ds_write_b128 v3, v[32:35] offset:2304
    s_mov_b64 exec, -1
    v_add_u32 v3, 384, v3
    s_mov_b64 vcc, 0
    s_mov_b32 s59, 0
    s_branch L_kblk
L_khead:
    ds_read_b128 v[12:15], v6 offset:512
    ds_read_b128 v[16:19], v6 offset:640
    ds_read_b128 v[20:23], v6 offset:768
    s_waitcnt lgkmcnt(0)
L_kblk:
    s_cbranch_vccnz L_kd
    s_cmp_lg_u32 s59, 0
    s_cbranch_scc1 L_kl
    s_waitcnt vmcnt(4)
    buffer_load_dwordx4 v[96:99], v2, s[32:35], s36 offen offset:0 nt
    v_dot2_f32_bf16 v24, v60, v12, 0
    v_dot2_f32_bf16 v24, v61, v13, v24
    v_dot2_f32_bf16 v24, v62, v14, v24
    v_dot2_f32_bf16 v24, v63, v15, v24
    ds_read_b32 v248, v249 offset:0
    v_mov_b32 v9, s51
    ds_write_b32 v5, v9 offset:0
    ds_read_b32 v7, v10 offset:56
    s_waitcnt vmcnt(4)
    buffer_load_dwordx4 v[100:103], v2, s[32:35], s36 offen offset:128 nt
    v_dot2_f32_bf16 v24, v64, v16, v24
    v_dot2_f32_bf16 v24, v65, v17, v24
    v_dot2_f32_bf16 v24, v66, v18, v24
    v_dot2_f32_bf16 v24, v67, v19, v24
    s_waitcnt vmcnt(4)
    buffer_load_dwordx4 v[104:107], v2, s[32:35], s36 offen offset:256 nt
    v_dot2_f32_bf16 v24, v68, v20, v24
    v_dot2_f32_bf16 v24, v69, v21, v24
    v_dot2_f32_bf16 v24, v70, v22, v24
    v_dot2_f32_bf16 v24, v71, v23, v24
    s_add_u32 s36, s36, 783360
    s_and_b32 s46, s51, 7
    s_cmp_eq_u32 s46, 7
    s_cselect_b32 s46, 88080384, 0
    s_add_u32 s36, s36, s46
    s_cmp_eq_u32 s51, 31
    s_cselect_b32 s32, s38, s32
    s_cselect_b32 s33, s39, s33
    s_cselect_b32 s36, s37, s36
    s_waitcnt vmcnt(4)
    buffer_load_dwordx4 v[60:63], v2, s[32:35], s36 offen offset:0 nt
    v_dot2_f32_bf16 v25, v72, v12, 0
    v_dot2_f32_bf16 v25, v73, v13, v25
    v_dot2_f32_bf16 v25, v74, v14, v25
    v_dot2_f32_bf16 v25, v75, v15, v25
    v_add_f32_dpp v24, v24, v24 quad_perm:[1,0,3,2] row_mask:0xf bank_mask:0xf
    s_waitcnt vmcnt(4)
    buffer_load_dwordx4 v[64:67], v2, s[32:35], s36 offen offset:128 nt
    v_dot2_f32_bf16 v25, v76, v16, v25
    v_dot2_f32_bf16 v25, v77, v17, v25
    v_dot2_f32_bf16 v25, v78, v18, v25
    v_dot2_f32_bf16 v25, v79, v19, v25
    v_add_f32_dpp v24, v24, v24 quad_perm:[2,3,0,1] row_mask:0xf bank_mask:0xf
    s_waitcnt vmcnt(4)
    buffer_load_dwordx4 v[68:71], v2, s[32:35], s36 offen offset:256 nt
    v_dot2_f32_bf16 v25, v80, v20, v25
    v_dot2_f32_bf16 v25, v81, v21, v25
    v_dot2_f32_bf16 v25, v82, v22, v25
    v_dot2_f32_bf16 v25, v83, v23, v25
    v_add_f32_dpp v24, v24, v24 row_half_mirror row_mask:0xf bank_mask:0xf
    s_add_u32 s36, s36, 3072
    s_waitcnt vmcnt(4)
    buffer_load_dwordx4 v[72:75], v2, s[32:35], s36 offen offset:0 nt
    v_dot2_f32_bf16 v26, v84, v12, 0
    v_dot2_f32_bf16 v26, v85, v13, v26
    v_dot2_f32_bf16 v26, v86, v14, v26
    v_dot2_f32_bf16 v26, v87, v15, v26
    v_add_f32_dpp v25, v25, v25 quad_perm:[1,0,3,2] row_mask:0xf bank_mask:0xf
    s_waitcnt lgkmcnt(0)
    v_readfirstlane_b32 s55, v7
    v_cmp_le_u32 vcc, s51, v248
    s_add_u32 s61, s51, 1
    s_and_b32 s61, s61, 7
    s_lshr_b32 s61, s55, s61
    s_and_b32 s47, vcc_lo, 15
    s_bcnt1_i32_b32 s47, s47
    s_waitcnt vmcnt(4)
    buffer_load_dwordx4 v[76:79], v2, s[32:35], s36 offen offset:128 nt
    v_dot2_f32_bf16 v26, v88, v16, v26
    v_dot2_f32_bf16 v26, v89, v17, v26
    v_dot2_f32_bf16 v26, v90, v18, v26
    v_dot2_f32_bf16 v26, v91, v19, v26
    v_add_f32_dpp v25, v25, v25 quad_perm:[2,3,0,1] row_mask:0xf bank_mask:0xf
    s_cmp_eq_u32 s47, 0
    s_cselect_b32 s59, -2, -1
    s_and_b32 s61, s61, s59
    s_cmp_ge_u32 s47, 3
    s_cselect_b32 s59, 0, 0x100
    s_and_b32 s59, s61, s59
    s_bitcmp1_b32 s61, 0
    s_cselect_b64 vcc, -1, 0
    s_waitcnt vmcnt(4)
    buffer_load_dwordx4 v[80:83], v2, s[32:35], s36 offen offset:256 nt
    v_dot2_f32_bf16 v26, v92, v20, v26
    v_dot2_f32_bf16 v26, v93, v21, v26
    v_dot2_f32_bf16 v26, v94, v22, v26
    v_dot2_f32_bf16 v26, v95, v23, v26
    v_add_f32_dpp v25, v25, v25 row_half_mirror row_mask:0xf bank_mask:0xf
    s_add_u32 s36, s36, 783360
    s_waitcnt vmcnt(4)
    buffer_load_dwordx4 v[84:87], v2, s[32:35], s36 offen offset:0 nt
    v_dot2_f32_bf16 v27, v96, v12, 0
    v_dot2_f32_bf16 v27, v97, v13, v27
    v_dot2_f32_bf16 v27, v98, v14, v27
    v_dot2_f32_bf16 v27, v99, v15, v27
    v_add_f32_dpp v26, v26, v26 quad_perm:[1,0,3,2] row_mask:0xf bank_mask:0xf
    s_waitcnt vmcnt(4)
    buffer_load_dwordx4 v[88:91], v2, s[32:35], s36 offen offset:128 nt
    v_dot2_f32_bf16 v27, v100, v16, v27
    v_dot2_f32_bf16 v27, v101, v17, v27
    v_dot2_f32_bf16 v27, v102, v18, v27
    v_dot2_f32_bf16 v27, v103, v19, v27
    v_add_f32_dpp v26, v26, v26 quad_perm:[2,3,0,1] row_mask:0xf bank_mask:0xf
    s_waitcnt vmcnt(4)
    buffer_load_dwordx4 v[92:95], v2, s[32:35], s36 offen offset:256 nt
    v_dot2_f32_bf16 v27, v104, v20, v27
    v_dot2_f32_bf16 v27, v105, v21, v27
    v_dot2_f32_bf16 v27, v106, v22, v27
    v_dot2_f32_bf16 v27, v107, v23, v27
    v_add_f32_dpp v26, v26, v26 row_half_mirror row_mask:0xf bank_mask:0xf
    s_add_u32 s36, s36, 3072
L_ke:
    s_nop 0
    v_add_f32_dpp v27, v27, v27 quad_perm:[1,0,3,2] row_mask:0xf bank_mask:0xf
    s_nop 1
    v_add_f32_dpp v27, v27, v27 quad_perm:[2,3,0,1] row_mask:0xf bank_mask:0xf
    s_nop 1
    v_add_f32_dpp v27, v27, v27 row_half_mirror row_mask:0xf bank_mask:0xf
    s_mov_b32 exec_lo, 0x01010101
    s_mov_b32 exec_hi, 0x01010101
    ds_write_b128 v3, v[24:27] offset:2048
    s_mov_b64 exec, -1
    v_add_u32 v3, 128, v3
    s_add_u32 s51, s51, 1
    s_and_b32 s46, s51, 7
    s_cbranch_scc1 L_kblk
    v_mov_b32 v9, s51
    ds_write_b32 v5, v9 offset:0
    v_add_u32 v6, 384, v6
    s_cmp_lt_u32 s51, 32
    s_cbranch_scc1 L_khead
    s_bitcmp1_b32 s69, 0
    s_cbranch_scc1 L_wpre
    s_bitcmp1_b32 s69, 1
    s_cbranch_scc1 L_fpre
L_vphase:
    v_subrev_u32 v3, 4096, v3
    s_mov_b32 s52, 0
    s_lshl_b32 s45, s28, 5
    s_add_u32 s45, s45, s29
    s_mul_i32 s45, s45, 3072
    s_add_u32 s45, s45, 131072
    v_mul_u32_u24 v6, 12, v1
    v_add_u32 v6, s45, v6
    v_mov_b32 v16, 1
    v_mov_b32 v8, 0
L_vhead:
    v_mov_b32 v36, 0
    v_mov_b32 v37, 0
    v_mov_b32 v38, 0
    v_mov_b32 v39, 0
    v_mov_b32 v40, 0
    v_mov_b32 v41, 0
    v_mov_b32 v42, 0
    v_mov_b32 v43, 0
    v_mov_b32 v44, 0
    v_mov_b32 v45, 0
    v_mov_b32 v46, 0
    v_mov_b32 v47, 0
    v_mov_b32 v48, 0
    v_mov_b32 v49, 0
    v_mov_b32 v50, 0
    v_mov_b32 v51, 0
    v_mov_b32 v52, 0
    v_mov_b32 v53, 0
    v_mov_b32 v54, 0
    v_mov_b32 v55, 0
    v_mov_b32 v56, 0
    v_mov_b32 v57, 0
    v_mov_b32 v58, 0
    v_mov_b32 v59, 0
L_vwait:
    ds_read_b32 v9, v10 offset:16
    ds_read_b128 v[28:31], v3 offset:2048
    s_waitcnt lgkmcnt(0)
    v_readfirstlane_b32 s46, v9
    s_nop 0
    s_cmp_gt_u32 s46, s52
    s_cbranch_scc1 L_vblk
    s_sub_u32 s44, s44, 1
    s_cmp_eq_u32 s44, 0
    s_cbranch_scc1 L_exit
    s_sleep 2
    s_branch L_vwait
L_vblk:
    s_waitcnt lgkmcnt(0)
    s_cmp_eq_u32 s51, 63
    s_cbranch_scc1 L_vlast
    s_cbranch_vccnz L_vd
    s_cmp_lg_u32 s59, 0
    s_cbranch_scc1 L_vl
    s_waitcnt vmcnt(4)
    buffer_load_dwordx4 v[96:99], v2, s[32:35], s36 offen offset:0 nt
    v_lshrrev_b32 v32, 16, v28
    v_dot2c_f32_bf16 v36, v60, v32
    v_dot2c_f32_bf16 v37, v60, v28
    v_dot2c_f32_bf16 v38, v61, v32
    v_dot2c_f32_bf16 v39, v61, v28
    v_dot2c_f32_bf16 v40, v62, v32
    v_dot2c_f32_bf16 v41, v62, v28
    v_dot2c_f32_bf16 v42, v63, v32
    v_dot2c_f32_bf16 v43, v63, v28
    ds_read_b32 v248, v249 offset:0
    v_mov_b32 v9, s51
    ds_write_b32 v5, v9 offset:0
    ds_read_b32 v7, v10 offset:56
    s_waitcnt vmcnt(4)
    buffer_load_dwordx4 v[100:103], v2, s[32:35], s36 offen offset:128 nt
    v_dot2c_f32_bf16 v44, v64, v32
    v_dot2c_f32_bf16 v45, v64, v28
    v_dot2c_f32_bf16 v46, v65, v32
    v_dot2c_f32_bf16 v47, v65, v28
    v_dot2c_f32_bf16 v48, v66, v32
    v_dot2c_f32_bf16 v49, v66, v28
    v_dot2c_f32_bf16 v50, v67, v32
    v_dot2c_f32_bf16 v51, v67, v28
    s_waitcnt vmcnt(4)
    buffer_load_dwordx4 v[104:107], v2, s[32:35], s36 offen offset:256 nt
    v_dot2c_f32_bf16 v52, v68, v32
    v_dot2c_f32_bf16 v53, v68, v28
    v_dot2c_f32_bf16 v54, v69, v32
    v_dot2c_f32_bf16 v55, v69, v28
    v_dot2c_f32_bf16 v56, v70, v32
    v_dot2c_f32_bf16 v57, v70, v28
    v_dot2c_f32_bf16 v58, v71, v32
    v_dot2c_f32_bf16 v59, v71, v28
    s_add_u32 s36, s36, 783360
    s_and_b32 s46, s51, 7
    s_cmp_eq_u32 s46, 7
    s_cselect_b32 s46, 88080384, 0
    s_add_u32 s36, s36, s46
    s_waitcnt vmcnt(4)
    buffer_load_dwordx4 v[60:63], v2, s[32:35], s36 offen offset:0 nt
    v_lshrrev_b32 v33, 16, v29
    v_dot2c_f32_bf16 v36, v72, v33
    v_dot2c_f32_bf16 v37, v72, v29
    v_dot2c_f32_bf16 v38, v73, v33
    v_dot2c_f32_bf16 v39, v73, v29
    v_dot2c_f32_bf16 v40, v74, v33
    v_dot2c_f32_bf16 v41, v74, v29
    v_dot2c_f32_bf16 v42, v75, v33
    v_dot2c_f32_bf16 v43, v75, v29
    s_waitcnt vmcnt(4)
    buffer_load_dwordx4 v[64:67], v2, s[32:35], s36 offen offset:128 nt
    v_dot2c_f32_bf16 v44, v76, v33
    v_dot2c_f32_bf16 v45, v76, v29
    v_dot2c_f32_bf16 v46, v77, v33
    v_dot2c_f32_bf16 v47, v77, v29
    v_dot2c_f32_bf16 v48, v78, v33
    v_dot2c_f32_bf16 v49, v78, v29
    v_dot2c_f32_bf16 v50, v79, v33
    v_dot2c_f32_bf16 v51, v79, v29
    s_waitcnt vmcnt(4)
    buffer_load_dwordx4 v[68:71], v2, s[32:35], s36 offen offset:256 nt
    v_dot2c_f32_bf16 v52, v80, v33
    v_dot2c_f32_bf16 v53, v80, v29
    v_dot2c_f32_bf16 v54, v81, v33
    v_dot2c_f32_bf16 v55, v81, v29
    v_dot2c_f32_bf16 v56, v82, v33
    v_dot2c_f32_bf16 v57, v82, v29
    v_dot2c_f32_bf16 v58, v83, v33
    v_dot2c_f32_bf16 v59, v83, v29
    s_add_u32 s36, s36, 3072
    s_waitcnt vmcnt(4)
    buffer_load_dwordx4 v[72:75], v2, s[32:35], s36 offen offset:0 nt
    v_lshrrev_b32 v34, 16, v30
    v_dot2c_f32_bf16 v36, v84, v34
    v_dot2c_f32_bf16 v37, v84, v30
    v_dot2c_f32_bf16 v38, v85, v34
    v_dot2c_f32_bf16 v39, v85, v30
    v_dot2c_f32_bf16 v40, v86, v34
    v_dot2c_f32_bf16 v41, v86, v30
    v_dot2c_f32_bf16 v42, v87, v34
    v_dot2c_f32_bf16 v43, v87, v30
    s_waitcnt lgkmcnt(0)
    v_readfirstlane_b32 s55, v7
    v_cmp_le_u32 vcc, s51, v248
    s_add_u32 s61, s51, 1
    s_and_b32 s61, s61, 7
    s_lshr_b32 s61, s55, s61
    s_and_b32 s47, vcc_lo, 15
    s_bcnt1_i32_b32 s47, s47
    s_waitcnt vmcnt(4)
    buffer_load_dwordx4 v[76:79], v2, s[32:35], s36 offen offset:128 nt
    v_dot2c_f32_bf16 v44, v88, v34
    v_dot2c_f32_bf16 v45, v88, v30
    v_dot2c_f32_bf16 v46, v89, v34
    v_dot2c_f32_bf16 v47, v89, v30
    v_dot2c_f32_bf16 v48, v90, v34
    v_dot2c_f32_bf16 v49, v90, v30
    v_dot2c_f32_bf16 v50, v91, v34
    v_dot2c_f32_bf16 v51, v91, v30
    s_cmp_eq_u32 s47, 0
    s_cselect_b32 s59, -2, -1
    s_and_b32 s61, s61, s59
    s_cmp_ge_u32 s47, 3
    s_cselect_b32 s59, 0, 0x100
    s_and_b32 s59, s61, s59
    s_bitcmp1_b32 s61, 0
    s_cselect_b64 vcc, -1, 0
    s_waitcnt vmcnt(4)
    buffer_load_dwordx4 v[80:83], v2, s[32:35], s36 offen offset:256 nt
    v_dot2c_f32_bf16 v52, v92, v34
    v_dot2c_f32_bf16 v53, v92, v30
    v_dot2c_f32_bf16 v54, v93, v34
    v_dot2c_f32_bf16 v55, v93, v30
    v_dot2c_f32_bf16 v56, v94, v34
    v_dot2c_f32_bf16 v57, v94, v30
    v_dot2c_f32_bf16 v58, v95, v34
    v_dot2c_f32_bf16 v59, v95, v30
    s_add_u32 s36, s36, 783360
    s_waitcnt vmcnt(4)
    buffer_load_dwordx4 v[84:87], v2, s[32:35], s36 offen offset:0 nt
    v_lshrrev_b32 v35, 16, v31
    v_mov_b32 v27, v31
    v_add_u32 v3, 128, v3
    ds_read_b128 v[28:31], v3 offset:2048
    v_dot2c_f32_bf16 v36, v96, v35
    v_dot2c_f32_bf16 v37, v96, v27
    v_dot2c_f32_bf16 v38, v97, v35
    v_dot2c_f32_bf16 v39, v97, v27
    v_dot2c_f32_bf16 v40, v98, v35
    v_dot2c_f32_bf16 v41, v98, v27
    v_dot2c_f32_bf16 v42, v99, v35
    v_dot2c_f32_bf16 v43, v99, v27
    s_waitcnt vmcnt(4)
    buffer_load_dwordx4 v[88:91], v2, s[32:35], s36 offen offset:128 nt
    v_dot2c_f32_bf16 v44, v100, v35
    v_dot2c_f32_bf16 v45, v100, v27
    v_dot2c_f32_bf16 v46, v101, v35
    v_dot2c_f32_bf16 v47, v101, v27
    v_dot2c_f32_bf16 v48, v102, v35
    v_dot2c_f32_bf16 v49, v102, v27
    v_dot2c_f32_bf16 v50, v103, v35
    v_dot2c_f32_bf16 v51, v103, v27
    s_waitcnt vmcnt(4)
    buffer_load_dwordx4 v[92:95], v2, s[32:35], s36 offen offset:256 nt
    v_dot2c_f32_bf16 v52, v104, v35
    v_dot2c_f32_bf16 v53, v104, v27
    v_dot2c_f32_bf16 v54, v105, v35
    v_dot2c_f32_bf16 v55, v105, v27
    v_dot2c_f32_bf16 v56, v106, v35
    v_dot2c_f32_bf16 v57, v106, v27
    v_dot2c_f32_bf16 v58, v107, v35
    v_dot2c_f32_bf16 v59, v107, v27
    s_add_u32 s36, s36, 3072
L_ve:
    s_add_u32 s51, s51, 1
    s_and_b32 s46, s51, 7
    s_cbranch_scc1 L_vblk
L_vhe:
    v_permlane32_swap_b32 v36, v48
    v_permlane32_swap_b32 v37, v49
    v_permlane32_swap_b32 v38, v50
    v_permlane32_swap_b32 v39, v51
    v_permlane32_swap_b32 v40, v52
    v_permlane32_swap_b32 v41, v53
    v_permlane32_swap_b32 v42, v54
    v_permlane32_swap_b32 v43, v55
    v_permlane32_swap_b32 v44, v56
    v_permlane32_swap_b32 v45, v57
    v_permlane32_swap_b32 v46, v58
    v_permlane32_swap_b32 v47, v59
    v_pk_add_f32 v[36:37], v[36:37], v[48:49]
    v_pk_add_f32 v[38:39], v[38:39], v[50:51]
    v_pk_add_f32 v[40:41], v[40:41], v[52:53]
    v_pk_add_f32 v[42:43], v[42:43], v[54:55]
    v_pk_add_f32 v[44:45], v[44:45], v[56:57]
    v_pk_add_f32 v[46:47], v[46:47], v[58:59]
    v_permlane16_swap_b32 v36, v42
    v_permlane16_swap_b32 v37, v43
    v_permlane16_swap_b32 v38, v44
    v_permlane16_swap_b32 v39, v45
    v_permlane16_swap_b32 v40, v46
    v_permlane16_swap_b32 v41, v47
    v_pk_add_f32 v[36:37], v[36:37], v[42:43]
    v_pk_add_f32 v[38:39], v[38:39], v[44:45]
    v_pk_add_f32 v[40:41], v[40:41], v[46:47]
    v_add_f32_dpp v42, v36, v36 row_ror:8 row_mask:0xf bank_mask:0x3
    v_add_f32_dpp v43, v37, v37 row_ror:8 row_mask:0xf bank_mask:0x3
    v_add_f32_dpp v44, v38, v38 row_ror:8 row_mask:0xf bank_mask:0x3
    v_add_f32_dpp v42, v39, v39 row_ror:8 row_mask:0xf bank_mask:0xc
    v_add_f32_dpp v43, v40, v40 row_ror:8 row_mask:0xf bank_mask:0xc
    v_add_f32_dpp v44, v41, v41 row_ror:8 row_mask:0xf bank_mask:0xc
    ds_write_b32 v11, v42 offset:18432
    ds_write_b32 v11, v43 offset:18688
    ds_write_b32 v11, v44 offset:18944
    s_mov_b64 exec, 1
    ds_add_rtn_u32 v9, v8, v16 offset:32
    s_mov_b64 exec, -1
    v_add_u32 v11, 3072, v11
    v_add_u32 v8, 4, v8
    s_add_u32 s52, s52, 1
    s_cmp_lt_u32 s52, 4
    s_cbranch_scc1 L_vhead
    ds_read_b32 v46, v4 offset:27648
    ds_read_b32 v50, v4 offset:27904
    ds_read_b32 v54, v4 offset:28160
    ds_read_b32 v47, v4 offset:28416
    ds_read_b32 v51, v4 offset:28672
    ds_read_b32 v55, v4 offset:28928
    ds_read_b32 v48, v4 offset:29184
    ds_read_b32 v52, v4 offset:29440
    ds_read_b32 v56, v4 offset:29696
    ds_read_b32 v49, v4 offset:29952
    ds_read_b32 v53, v4 offset:30208
    ds_read_b32 v57, v4 offset:30464
    v_mov_b32 v36, s51
    ds_write_b32 v5, v36 offset:0
    s_waitcnt lgkmcnt(0)
    v_readfirstlane_b32 s46, v9
    s_nop 0
    s_cmp_lg_u32 s46, 3
    s_cbranch_scc1 L_vend
    v_pk_add_f32 v[46:47], v[46:47], v[48:49]
    v_pk_add_f32 v[50:51], v[50:51], v[52:53]
    v_pk_add_f32 v[54:55], v[54:55], v[56:57]
    v_add_f32 v200, v46, v47
    v_add_f32 v201, v50, v51
    v_add_f32 v202, v54, v55
    v_min_u32 v200, -2, v200
    v_min_u32 v201, -2, v201
    v_min_u32 v202, -2, v202
    global_store_dwordx3 v6, v[200:202], s[26:27] offset:2304 sc1
L_vend:
    s_bitcmp1_b32 s69, 1
    s_cbranch_scc1 L_ffn
    s_bitcmp0_b32 s69, 0
    s_cbranch_scc1 L_fin
    global_load_dwordx3 v[44:46], v156, s[26:27] sc1
    global_load_dwordx3 v[48:50], v157, s[26:27] sc1
    global_load_dwordx3 v[52:54], v158, s[26:27] sc1
    global_load_dwordx3 v[56:58], v159, s[26:27] sc1
    global_load_dwordx3 v[60:62], v160, s[26:27] sc1
    global_load_dwordx3 v[64:66], v161, s[26:27] sc1
    global_load_dwordx3 v[68:70], v162, s[26:27] sc1
    global_load_dwordx3 v[72:74], v163, s[26:27] sc1
    global_load_dwordx3 v[76:78], v164, s[26:27] sc1
    global_load_dwordx3 v[80:82], v165, s[26:27] sc1
    global_load_dwordx3 v[84:86], v166, s[26:27] sc1
    global_load_dwordx3 v[88:90], v167, s[26:27] sc1
    global_load_dwordx3 v[92:94], v168, s[26:27] sc1
    global_load_dwordx3 v[96:98], v169, s[26:27] sc1
    global_load_dwordx3 v[100:102], v170, s[26:27] sc1
    global_load_dwordx3 v[104:106], v171, s[26:27] sc1
    s_mul_i32 s46, s30, 192
    v_bfe_u32 v3, v1, 3, 2
    v_and_b32 v9, 7, v1
    v_mul_u32_u24 v3, 48, v3
    v_lshl_add_u32 v3, v9, 1, v3
    v_add_u32 v3, s46, v3
    v_lshrrev_b32 v9, 4, v1
    v_mul_u32_u24 v7, 48, v9
    v_add_u32 v7, s46, v7
    s_lshl_b32 s46, s30, 8
    v_add_u32 v8, s46, v4
    v_add_u32 v11, s53, v4
    v_mov_b32 v24, 0
    v_mov_b32 v25, 0
    v_mov_b32 v26, 0
    v_mov_b32 v27, 0
    v_mov_b32 v5, 1
    s_branch L_x1w
L_x1:
    global_load_dwordx3 v[44:46], v156, s[26:27] sc1
    global_load_dwordx3 v[48:50], v157, s[26:27] sc1
    global_load_dwordx3 v[52:54], v158, s[26:27] sc1
    global_load_dwordx3 v[56:58], v159, s[26:27] sc1
    global_load_dwordx3 v[60:62], v160, s[26:27] sc1
    global_load_dwordx3 v[64:66], v161, s[26:27] sc1
    global_load_dwordx3 v[68:70], v162, s[26:27] sc1
    global_load_dwordx3 v[72:74], v163, s[26:27] sc1
    global_load_dwordx3 v[76:78], v164, s[26:27] sc1
    global_load_dwordx3 v[80:82], v165, s[26:27] sc1
    global_load_dwordx3 v[84:86], v166, s[26:27] sc1
    global_load_dwordx3 v[88:90], v167, s[26:27] sc1
    global_load_dwordx3 v[92:94], v168, s[26:27] sc1
    global_load_dwordx3 v[96:98], v169, s[26:27] sc1
    global_load_dwordx3 v[100:102], v170, s[26:27] sc1
    global_load_dwordx3 v[104:106], v171, s[26:27] sc1
L_x1w:
    s_waitcnt vmcnt(14)
    v_pk_add_f32 v[28:29], v[44:45], v[48:49]
    v_add_f32 v30, v46, v50
    s_waitcnt vmcnt(12)
    v_pk_add_f32 v[32:33], v[52:53], v[56:57]
    v_add_f32 v34, v54, v58
    v_pk_add_f32 v[28:29], v[28:29], v[32:33]
    v_add_f32 v30, v30, v34
    s_waitcnt vmcnt(10)
    v_pk_add_f32 v[32:33], v[60:61], v[64:65]
    v_add_f32 v34, v62, v66
    v_pk_add_f32 v[28:29], v[28:29], v[32:33]
    v_add_f32 v30, v30, v34
    s_waitcnt vmcnt(8)
    v_pk_add_f32 v[32:33], v[68:69], v[72:73]
    v_add_f32 v34, v70, v74
    v_pk_add_f32 v[28:29], v[28:29], v[32:33]
    v_add_f32 v30, v30, v34
    s_waitcnt vmcnt(6)
    v_pk_add_f32 v[32:33], v[76:77], v[80:81]
    v_add_f32 v34, v78, v82
    v_pk_add_f32 v[28:29], v[28:29], v[32:33]
    v_add_f32 v30, v30, v34
    s_waitcnt vmcnt(4)
    v_pk_add_f32 v[32:33], v[84:85], v[88:89]
    v_add_f32 v34, v86, v90
    v_pk_add_f32 v[28:29], v[28:29], v[32:33]
    v_add_f32 v30, v30, v34
    s_waitcnt vmcnt(2)
    v_pk_add_f32 v[32:33], v[92:93], v[96:97]
    v_add_f32 v34, v94, v98
    v_pk_add_f32 v[28:29], v[28:29], v[32:33]
    v_add_f32 v30, v30, v34
    s_waitcnt vmcnt(0)
    v_pk_add_f32 v[32:33], v[100:101], v[104:105]
    v_add_f32 v34, v102, v106
    v_pk_add_f32 v[28:29], v[28:29], v[32:33]
    v_add_f32 v30, v30, v34
    v_add_f32 v31, v28, v29
    v_mov_b32 v32, v28
    v_mov_b32 v33, v29
    v_mov_b32 v34, v30
    v_cmp_u_f32 vcc, v31, v30
    s_cbranch_vccnz L_x1c
L_x1ok:
    v_permlane32_swap_b32 v28, v32
    v_permlane32_swap_b32 v29, v33
    v_permlane32_swap_b32 v30, v34
    v_add_f32 v28, v28, v32
    v_cvt_pk_bf16_f32 v28, v28, v28
    ds_write_b16 v3, v28 offset:30720
    v_add_f32 v29, v29, v33
    v_cvt_pk_bf16_f32 v29, v29, v29
    ds_write_b16 v3, v29 offset:30736
    v_add_f32 v30, v30, v34
    v_cvt_pk_bf16_f32 v30, v30, v30
    ds_write_b16 v3, v30 offset:30752
    ds_read_b128 v[12:15], v7 offset:30720
    ds_read_b128 v[16:19], v7 offset:30736
    ds_read_b128 v[20:23], v7 offset:30752
    s_waitcnt lgkmcnt(2)
    v_dot2c_f32_bf16 v24, v108, v12
    v_dot2c_f32_bf16 v25, v109, v12
    v_dot2c_f32_bf16 v26, v110, v12
    v_dot2c_f32_bf16 v27, v111, v12
    v_dot2c_f32_bf16 v24, v112, v13
    v_dot2c_f32_bf16 v25, v113, v13
    v_dot2c_f32_bf16 v26, v114, v13
    v_dot2c_f32_bf16 v27, v115, v13
    v_dot2c_f32_bf16 v24, v116, v14
    v_dot2c_f32_bf16 v25, v117, v14
    v_dot2c_f32_bf16 v26, v118, v14
    v_dot2c_f32_bf16 v27, v119, v14
    v_dot2c_f32_bf16 v24, v120, v15
    v_dot2c_f32_bf16 v25, v121, v15
    v_dot2c_f32_bf16 v26, v122, v15
    v_dot2c_f32_bf16 v27, v123, v15
    s_waitcnt lgkmcnt(1)
    v_dot2c_f32_bf16 v24, v124, v16
    v_dot2c_f32_bf16 v25, v125, v16
    v_dot2c_f32_bf16 v26, v126, v16
    v_dot2c_f32_bf16 v27, v127, v16
    v_dot2c_f32_bf16 v24, v128, v17
    v_dot2c_f32_bf16 v25, v129, v17
    v_dot2c_f32_bf16 v26, v130, v17
    v_dot2c_f32_bf16 v27, v131, v17
    v_dot2c_f32_bf16 v24, v132, v18
    v_dot2c_f32_bf16 v25, v133, v18
    v_dot2c_f32_bf16 v26, v134, v18
    v_dot2c_f32_bf16 v27, v135, v18
    v_dot2c_f32_bf16 v24, v136, v19
    v_dot2c_f32_bf16 v25, v137, v19
    v_dot2c_f32_bf16 v26, v138, v19
    v_dot2c_f32_bf16 v27, v139, v19
    s_waitcnt lgkmcnt(0)
    v_dot2c_f32_bf16 v24, v140, v20
    v_dot2c_f32_bf16 v25, v141, v20
    v_dot2c_f32_bf16 v26, v142, v20
    v_dot2c_f32_bf16 v27, v143, v20
    v_dot2c_f32_bf16 v24, v144, v21
    v_dot2c_f32_bf16 v25, v145, v21
    v_dot2c_f32_bf16 v26, v146, v21
    v_dot2c_f32_bf16 v27, v147, v21
    v_dot2c_f32_bf16 v24, v148, v22
    v_dot2c_f32_bf16 v25, v149, v22
    v_dot2c_f32_bf16 v26, v150, v22
    v_dot2c_f32_bf16 v27, v151, v22
    v_dot2c_f32_bf16 v24, v152, v23
    v_dot2c_f32_bf16 v25, v153, v23
    v_dot2c_f32_bf16 v26, v154, v23
    v_dot2c_f32_bf16 v27, v155, v23
    s_nop 1
    v_permlane32_swap_b32 v24, v26
    v_permlane32_swap_b32 v25, v27
    v_pk_add_f32 v[24:25], v[24:25], v[26:27]
    s_nop 1
    v_permlane16_swap_b32 v24, v25
    v_add_f32 v24, v24, v25
    ds_write_b32 v8, v24 offset:31744
    s_mov_b64 exec, 1
    ds_add_rtn_u32 v9, v10, v5 offset:48
    s_mov_b64 exec, -1
    ds_read2st64_b32 v[28:29], v4 offset0:124 offset1:125
    ds_read2st64_b32 v[30:31], v4 offset0:126 offset1:127
    s_waitcnt lgkmcnt(0)
    v_readfirstlane_b32 s46, v9
    v_pk_add_f32 v[28:29], v[28:29], v[30:31]
    s_cmp_lg_u32 s46, 3
    s_cbranch_scc1 L_red
    v_add_f32 v28, v28, v29
    v_min_u32 v28, -2, v28
    global_store_dword v11, v28, s[26:27] sc1
L_red:
    s_bitcmp0_b32 s69, 2
    s_cbranch_scc1 L_fin
    s_cmp_lg_u32 s30, 0
    s_cbranch_scc1 L_fin
    s_load_dword s31, s[26:27], 0
    s_lshl_b32 s47, s71, 6
    s_add_u32 s47, s47, 1048576
    v_lshrrev_b32 v6, 2, v1
    v_mul_u32_u24 v6, 2560, v6
    v_and_b32 v7, 3, v1
    v_lshl_add_u32 v6, v7, 4, v6
    v_add_u32 v3, s47, v6
    v_add_u32 v4, 40960, v3
    v_add_u32 v5, 81920, v3
    v_lshrrev_b32 v8, 4, v1
    v_lshl_add_u32 v8, v7, 2, v8
    s_lshl_b32 s47, s71, 4
    v_add_u32 v8, s47, v8
    v_bfe_u32 v6, v8, 2, 4
    v_and_b32 v7, 3, v8
    v_lshl_add_u32 v6, v7, 4, v6
    v_and_b32 v7, 0x3c0, v8
    v_add_lshl_u32 v6, v6, v7, 2
    v_add_u32 v6, 1171456, v6
    v_lshlrev_b32 v8, 1, v8
L_rh:
    global_load_dword v12, v6, s[26:27] sc1
    s_waitcnt vmcnt(0)
    v_cmp_eq_u32 vcc, -1, v12
    s_cbranch_vccz L_x3
    s_sub_u32 s44, s44, 1
    s_cmp_eq_u32 s44, 0
    s_cbranch_scc1 L_exit
    s_sleep 2
    s_branch L_rh
L_x3:
    global_load_dwordx4 v[60:63], v3, s[26:27] sc1
    global_load_dwordx4 v[64:67], v4, s[26:27] sc1
    global_load_dwordx4 v[68:71], v5, s[26:27] sc1
    global_load_dwordx4 v[72:75], v3, s[26:27] sc1
    global_load_dwordx4 v[76:79], v4, s[26:27] sc1
    global_load_dwordx4 v[80:83], v5, s[26:27] sc1
    global_load_dwordx4 v[84:87], v3, s[26:27] sc1
    global_load_dwordx4 v[88:91], v4, s[26:27] sc1
    global_load_dwordx4 v[92:95], v5, s[26:27] sc1
L_x3l:
    global_load_dwordx4 v[96:99], v3, s[26:27] sc1
    global_load_dwordx4 v[100:103], v4, s[26:27] sc1
    global_load_dwordx4 v[104:107], v5, s[26:27] sc1
    s_waitcnt vmcnt(9)
    v_pk_add_f32 v[36:37], v[60:61], v[64:65]
    v_pk_add_f32 v[38:39], v[62:63], v[66:67]
    v_pk_add_f32 v[36:37], v[36:37], v[68:69]
    v_pk_add_f32 v[38:39], v[38:39], v[70:71]
    v_max_u32 v40, v60, v61
    v_max3_u32 v40, v62, v63, v40
    v_max3_u32 v40, v64, v65, v40
    v_max3_u32 v40, v66, v67, v40
    v_max3_u32 v40, v68, v69, v40
    v_max3_u32 v40, v70, v71, v40
    v_cmp_eq_u32 vcc, -1, v40
    s_cbranch_vccz L_x3ok
    global_load_dwordx4 v[60:63], v3, s[26:27] sc1
    global_load_dwordx4 v[64:67], v4, s[26:27] sc1
    global_load_dwordx4 v[68:71], v5, s[26:27] sc1
    s_waitcnt vmcnt(9)
    v_pk_add_f32 v[36:37], v[72:73], v[76:77]
    v_pk_add_f32 v[38:39], v[74:75], v[78:79]
    v_pk_add_f32 v[36:37], v[36:37], v[80:81]
    v_pk_add_f32 v[38:39], v[38:39], v[82:83]
    v_max_u32 v40, v72, v73
    v_max3_u32 v40, v74, v75, v40
    v_max3_u32 v40, v76, v77, v40
    v_max3_u32 v40, v78, v79, v40
    v_max3_u32 v40, v80, v81, v40
    v_max3_u32 v40, v82, v83, v40
    v_cmp_eq_u32 vcc, -1, v40
    s_cbranch_vccz L_x3ok
    global_load_dwordx4 v[72:75], v3, s[26:27] sc1
    global_load_dwordx4 v[76:79], v4, s[26:27] sc1
    global_load_dwordx4 v[80:83], v5, s[26:27] sc1
    s_waitcnt vmcnt(9)
    v_pk_add_f32 v[36:37], v[84:85], v[88:89]
    v_pk_add_f32 v[38:39], v[86:87], v[90:91]
    v_pk_add_f32 v[36:37], v[36:37], v[92:93]
    v_pk_add_f32 v[38:39], v[38:39], v[94:95]
    v_max_u32 v40, v84, v85
    v_max3_u32 v40, v86, v87, v40
    v_max3_u32 v40, v88, v89, v40
    v_max3_u32 v40, v90, v91, v40
    v_max3_u32 v40, v92, v93, v40
    v_max3_u32 v40, v94, v95, v40
    v_cmp_eq_u32 vcc, -1, v40
    s_cbranch_vccz L_x3ok
    global_load_dwordx4 v[84:87], v3, s[26:27] sc1
    global_load_dwordx4 v[88:91], v4, s[26:27] sc1
    global_load_dwordx4 v[92:95], v5, s[26:27] sc1
    s_waitcnt vmcnt(9)
    v_pk_add_f32 v[36:37], v[96:97], v[100:101]
    v_pk_add_f32 v[38:39], v[98:99], v[102:103]
    v_pk_add_f32 v[36:37], v[36:37], v[104:105]
    v_pk_add_f32 v[38:39], v[38:39], v[106:107]
    v_max_u32 v40, v96, v97
    v_max3_u32 v40, v98, v99, v40
    v_max3_u32 v40, v100, v101, v40
    v_max3_u32 v40, v102, v103, v40
    v_max3_u32 v40, v104, v105, v40
    v_max3_u32 v40, v106, v107, v40
    v_cmp_eq_u32 vcc, -1, v40
    s_cbranch_vccz L_x3ok
    s_sub_u32 s44, s44, 1
    s_cmp_eq_u32 s44, 0
    s_cbranch_scc1 L_exit
    s_branch L_x3l
L_x3ok:
    v_permlane32_swap_b32 v36, v38
    v_permlane32_swap_b32 v37, v39
    v_pk_add_f32 v[36:37], v[36:37], v[38:39]
    s_nop 1
    v_permlane16_swap_b32 v36, v37
    v_add_f32 v36, v36, v37
    s_nop 1
    v_add_f32_dpp v36, v36, v36 row_ror:8 row_mask:0xf bank_mask:0xf
    s_nop 1
    v_add_f32_dpp v36, v36, v36 row_ror:4 row_mask:0xf bank_mask:0xf
    v_cvt_pk_bf16_f32 v36, 0, v36
    v_add_f32 v36, v36, v12
    v_cvt_pk_bf16_f32 v36, v36, v36
    s_mov_b32 exec_lo, 0x000f000f
    s_mov_b32 exec_hi, 0x000f000f
    global_store_short v8, v36, s[22:23]
    s_cmp_lg_u32 s71, 0
    s_cbranch_scc1 L_fin
    s_waitcnt lgkmcnt(0)
    s_add_u32 s46, s31, 1
    v_mov_b32 v6, s46
    s_mov_b64 exec, 1
    global_store_dword v10, v6, s[26:27] offset:0
L_fin:
L_exit:
    s_endpgm
L_x1c:
    v_max_u32 v31, v44, v45
    v_max3_u32 v31, v46, v48, v31
    v_max3_u32 v31, v49, v50, v31
    v_max3_u32 v31, v52, v53, v31
    v_max3_u32 v31, v54, v56, v31
    v_max3_u32 v31, v57, v58, v31
    v_max3_u32 v31, v60, v61, v31
    v_max3_u32 v31, v62, v64, v31
    v_max3_u32 v31, v65, v66, v31
    v_max3_u32 v31, v68, v69, v31
    v_max3_u32 v31, v70, v72, v31
    v_max3_u32 v31, v73, v74, v31
    v_max3_u32 v31, v76, v77, v31
    v_max3_u32 v31, v78, v80, v31
    v_max3_u32 v31, v81, v82, v31
    v_max3_u32 v31, v84, v85, v31
    v_max3_u32 v31, v86, v88, v31
    v_max3_u32 v31, v89, v90, v31
    v_max3_u32 v31, v92, v93, v31
    v_max3_u32 v31, v94, v96, v31
    v_max3_u32 v31, v97, v98, v31
    v_max3_u32 v31, v100, v101, v31
    v_max3_u32 v31, v102, v104, v31
    v_max3_u32 v31, v105, v106, v31
    v_cmp_eq_u32 vcc, -1, v31
    s_cbranch_vccz L_x1ok
    s_sub_u32 s44, s44, 1
    s_cmp_eq_u32 s44, 0
    s_cbranch_scc1 L_exit
    s_branch L_x1
L_ffn:
    v_lshrrev_b32 v25, 2, v1
    v_and_b32 v26, 3, v1
    v_mul_u32_u24 v25, 12288, v25
    v_lshl_add_u32 v25, v26, 4, v25
    v_lshlrev_b32 v26, 4, v1
    s_mov_b32 s72, s18
    s_mov_b32 s73, s19
    s_mov_b32 s74, 1966080
    s_mov_b32 s75, 0x20000
    s_lshl_b32 s47, s71, 6
    s_mul_i32 s46, s30, 3072
    s_add_u32 s47, s47, s46
    s_add_u32 s47, s47, 1179648
    s_lshl_b32 s70, s30, 10
    s_add_u32 s70, s70, 98816
    s_mov_b32 m0, s70
    s_add_u32 s70, s70, 4096
    buffer_load_dwordx4 v25, s[72:75], s47 offen nt lds
    s_add_u32 s47, s47, 196608
    s_mov_b32 m0, s70
    s_add_u32 s70, s70, 4096
    buffer_load_dwordx4 v25, s[72:75], s47 offen nt lds
    s_add_u32 s47, s47, 196608
    s_mov_b32 m0, s70
    s_add_u32 s70, s70, 4096
    buffer_load_dwordx4 v25, s[72:75], s47 offen nt lds
    s_add_u32 s47, s47, 196608
    s_mov_b32 m0, s70
    s_add_u32 s70, s70, 4096
    buffer_load_dwordx4 v25, s[72:75], s47 offen nt lds
    s_add_u32 s47, s47, 196608
    s_mov_b32 s72, s20
    s_mov_b32 s73, s21
    s_mov_b32 s74, 1966080
    s_lshl_b32 s47, s71, 2
    s_add_u32 s47, s47, s30
    s_mul_i32 s47, s47, 10240
    s_mul_i32 s70, s30, 10240
    s_add_u32 s70, s70, 115200
    s_mov_b32 m0, s70
    s_add_u32 s70, s70, 1024
    buffer_load_dwordx4 v26, s[72:75], s47 offen nt lds
    s_add_u32 s47, s47, 1024
    s_mov_b32 m0, s70
    s_add_u32 s70, s70, 1024
    buffer_load_dwordx4 v26, s[72:75], s47 offen nt lds
    s_add_u32 s47, s47, 1024
    s_mov_b32 m0, s70
    s_add_u32 s70, s70, 1024
    buffer_load_dwordx4 v26, s[72:75], s47 offen nt lds
    s_add_u32 s47, s47, 1024
    s_mov_b32 m0, s70
    s_add_u32 s70, s70, 1024
    buffer_load_dwordx4 v26, s[72:75], s47 offen nt lds
    s_add_u32 s47, s47, 1024
    s_mov_b32 m0, s70
    s_add_u32 s70, s70, 1024
    buffer_load_dwordx4 v26, s[72:75], s47 offen nt lds
    s_add_u32 s47, s47, 1024
    s_mov_b32 m0, s70
    s_add_u32 s70, s70, 1024
    buffer_load_dwordx4 v26, s[72:75], s47 offen nt lds
    s_add_u32 s47, s47, 1024
    s_mov_b32 m0, s70
    s_add_u32 s70, s70, 1024
    buffer_load_dwordx4 v26, s[72:75], s47 offen nt lds
    s_add_u32 s47, s47, 1024
    s_mov_b32 m0, s70
    s_add_u32 s70, s70, 1024
    buffer_load_dwordx4 v26, s[72:75], s47 offen nt lds
    s_add_u32 s47, s47, 1024
    s_mov_b32 m0, s70
    s_add_u32 s70, s70, 1024
    buffer_load_dwordx4 v26, s[72:75], s47 offen nt lds
    s_add_u32 s47, s47, 1024
    s_mov_b32 m0, s70
    s_add_u32 s70, s70, 1024
    buffer_load_dwordx4 v26, s[72:75], s47 offen nt lds
    s_add_u32 s47, s47, 1024
    s_mul_i32 s45, s30, 640
    v_min_u32 v9, 39, v1
    v_lshl_add_u32 v3, v9, 4, s45
    v_add_u32 v14, 51712, v3
    v_add_u32 v15, 59392, v3
    v_add_u32 v16, 67072, v3
    v_add_u32 v17, 74752, v3
    v_add_u32 v18, 82432, v3
    v_add_u32 v19, 90112, v3
    v_add_u32 v4, 30720, v4
    s_mul_i32 s46, s71, 2560
    s_add_u32 s46, s46, 1048576
    v_add_u32 v5, s46, v3
    v_add_u32 v6, 1171456, v3
    s_mul_i32 s46, s30, 2560
    s_add_u32 s46, s46, 2048
    v_lshl_add_u32 v7, v1, 4, s46
    v_lshl_add_u32 v8, v1, 3, s46
    v_add_u32 v9, 2048, v3
    s_lshl_b32 s46, s30, 3
    v_mov_b32 v11, s46
    v_mov_b32 v248, 0x3acccccd
    v_mov_b32 v12, 0
    v_mov_b32 v13, 0
    s_lshl_b32 s46, s30, 4
    s_add_u32 s46, s46, 74240
    v_lshl_add_u32 v36, v1, 6, s46
    s_waitcnt vmcnt(10)
    s_barrier
    ds_read_b128 v[60:63], v36 offset:24576
    ds_read_b128 v[64:67], v36 offset:28672
    ds_read_b128 v[68:71], v36 offset:32768
    ds_read_b128 v[72:75], v36 offset:36864
    s_waitcnt lgkmcnt(2)
    v_perm_b32 v164, v64, v60, s42
    v_perm_b32 v165, v64, v60, s43
    v_perm_b32 v166, v65, v61, s42
    v_perm_b32 v167, v65, v61, s43
    v_perm_b32 v168, v66, v62, s42
    v_perm_b32 v169, v66, v62, s43
    v_perm_b32 v170, v67, v63, s42
    v_perm_b32 v171, v67, v63, s43
    s_waitcnt lgkmcnt(0)
    v_perm_b32 v180, v72, v68, s42
    v_perm_b32 v181, v72, v68, s43
    v_perm_b32 v182, v73, v69, s42
    v_perm_b32 v183, v73, v69, s43
    v_perm_b32 v184, v74, v70, s42
    v_perm_b32 v185, v74, v70, s43
    v_perm_b32 v186, v75, v71, s42
    v_perm_b32 v187, v75, v71, s43
    s_mov_b32 exec_hi, 0xff
    global_load_dwordx4 v[44:47], v14, s[26:27] offset:-2560 sc1
    global_load_dwordx4 v[48:51], v14, s[26:27] offset:0 sc1
    global_load_dwordx4 v[52:55], v14, s[26:27] offset:2560 sc1
    global_load_dwordx4 v[56:59], v15, s[26:27] offset:-2560 sc1
    global_load_dwordx4 v[60:63], v15, s[26:27] offset:0 sc1
    global_load_dwordx4 v[64:67], v15, s[26:27] offset:2560 sc1
    global_load_dwordx4 v[68:71], v16, s[26:27] offset:-2560 sc1
    global_load_dwordx4 v[72:75], v16, s[26:27] offset:0 sc1
    global_load_dwordx4 v[76:79], v16, s[26:27] offset:2560 sc1
    global_load_dwordx4 v[80:83], v17, s[26:27] offset:-2560 sc1
    global_load_dwordx4 v[84:87], v17, s[26:27] offset:0 sc1
    global_load_dwordx4 v[88:91], v17, s[26:27] offset:2560 sc1
    global_load_dwordx4 v[92:95], v18, s[26:27] offset:-2560 sc1
    global_load_dwordx4 v[96:99], v18, s[26:27] offset:0 sc1
    global_load_dwordx4 v[100:103], v18, s[26:27] offset:2560 sc1
    global_load_dwordx4 v[104:107], v19, s[26:27] offset:-2560 sc1
    s_mov_b64 exec, -1
    s_mul_i32 s46, s30, 10240
    s_add_u32 s46, s46, 115200
    v_lshl_add_u32 v36, v1, 3, s46
    v_lshl_add_u32 v37, v1, 2, s46
    s_waitcnt vmcnt(16)
    ds_read_b64 v[24:25], v36 offset:0
    ds_read_b64 v[26:27], v36 offset:512
    ds_read_b32 v28, v37 offset:1024
    ds_read_b64 v[30:31], v36 offset:1280
    ds_read_b64 v[32:33], v36 offset:1792
    ds_read_b32 v34, v37 offset:2304
    s_waitcnt lgkmcnt(0)
    v_perm_b32 v204, v30, v24, s42
    v_perm_b32 v205, v30, v24, s43
    v_perm_b32 v206, v31, v25, s42
    v_perm_b32 v207, v31, v25, s43
    v_perm_b32 v208, v32, v26, s42
    v_perm_b32 v209, v32, v26, s43
    v_perm_b32 v210, v33, v27, s42
    v_perm_b32 v211, v33, v27, s43
    v_perm_b32 v212, v34, v28, s42
    v_perm_b32 v213, v34, v28, s43
    ds_read_b64 v[24:25], v36 offset:2560
    ds_read_b64 v[26:27], v36 offset:3072
    ds_read_b32 v28, v37 offset:3584
    ds_read_b64 v[30:31], v36 offset:3840
    ds_read_b64 v[32:33], v36 offset:4352
    ds_read_b32 v34, v37 offset:4864
    s_waitcnt lgkmcnt(0)
    v_perm_b32 v214, v30, v24, s42
    v_perm_b32 v215, v30, v24, s43
    v_perm_b32 v216, v31, v25, s42
    v_perm_b32 v217, v31, v25, s43
    v_perm_b32 v218, v32, v26, s42
    v_perm_b32 v219, v32, v26, s43
    v_perm_b32 v220, v33, v27, s42
    v_perm_b32 v221, v33, v27, s43
    v_perm_b32 v222, v34, v28, s42
    v_perm_b32 v223, v34, v28, s43
    ds_read_b64 v[24:25], v36 offset:5120
    ds_read_b64 v[26:27], v36 offset:5632
    ds_read_b32 v28, v37 offset:6144
    ds_read_b64 v[30:31], v36 offset:6400
    ds_read_b64 v[32:33], v36 offset:6912
    ds_read_b32 v34, v37 offset:7424
    s_waitcnt lgkmcnt(0)
    v_perm_b32 v224, v30, v24, s42
    v_perm_b32 v225, v30, v24, s43
    v_perm_b32 v226, v31, v25, s42
    v_perm_b32 v227, v31, v25, s43
    v_perm_b32 v228, v32, v26, s42
    v_perm_b32 v229, v32, v26, s43
    v_perm_b32 v230, v33, v27, s42
    v_perm_b32 v231, v33, v27, s43
    v_perm_b32 v232, v34, v28, s42
    v_perm_b32 v233, v34, v28, s43
    ds_read_b64 v[24:25], v36 offset:7680
    ds_read_b64 v[26:27], v36 offset:8192
    ds_read_b32 v28, v37 offset:8704
    ds_read_b64 v[30:31], v36 offset:8960
    ds_read_b64 v[32:33], v36 offset:9472
    ds_read_b32 v34, v37 offset:9984
    s_waitcnt lgkmcnt(0)
    v_perm_b32 v234, v30, v24, s42
    v_perm_b32 v235, v30, v24, s43
    v_perm_b32 v236, v31, v25, s42
    v_perm_b32 v237, v31, v25, s43
    v_perm_b32 v238, v32, v26, s42
    v_perm_b32 v239, v32, v26, s43
    v_perm_b32 v240, v33, v27, s42
    v_perm_b32 v241, v33, v27, s43
    v_perm_b32 v242, v34, v28, s42
    v_perm_b32 v243, v34, v28, s43
    s_mov_b32 exec_hi, 0xff
    s_branch L_x2a
L_x2:
    global_load_dwordx4 v[44:47], v14, s[26:27] offset:-2560 sc1
    global_load_dwordx4 v[48:51], v14, s[26:27] offset:0 sc1
    global_load_dwordx4 v[52:55], v14, s[26:27] offset:2560 sc1
    global_load_dwordx4 v[56:59], v15, s[26:27] offset:-2560 sc1
    global_load_dwordx4 v[60:63], v15, s[26:27] offset:0 sc1
    global_load_dwordx4 v[64:67], v15, s[26:27] offset:2560 sc1
    global_load_dwordx4 v[68:71], v16, s[26:27] offset:-2560 sc1
    global_load_dwordx4 v[72:75], v16, s[26:27] offset:0 sc1
    global_load_dwordx4 v[76:79], v16, s[26:27] offset:2560 sc1
    global_load_dwordx4 v[80:83], v17, s[26:27] offset:-2560 sc1
    global_load_dwordx4 v[84:87], v17, s[26:27] offset:0 sc1
    global_load_dwordx4 v[88:91], v17, s[26:27] offset:2560 sc1
    global_load_dwordx4 v[92:95], v18, s[26:27] offset:-2560 sc1
    global_load_dwordx4 v[96:99], v18, s[26:27] offset:0 sc1
    global_load_dwordx4 v[100:103], v18, s[26:27] offset:2560 sc1
    global_load_dwordx4 v[104:107], v19, s[26:27] offset:-2560 sc1
L_x2a:
    s_waitcnt vmcnt(14)
    v_pk_add_f32 v[20:21], v[44:45], v[48:49]
    v_pk_add_f32 v[22:23], v[46:47], v[50:51]
    s_waitcnt vmcnt(12)
    v_pk_add_f32 v[24:25], v[52:53], v[56:57]
    v_pk_add_f32 v[26:27], v[54:55], v[58:59]
    v_pk_add_f32 v[20:21], v[20:21], v[24:25]
    v_pk_add_f32 v[22:23], v[22:23], v[26:27]
    s_waitcnt vmcnt(10)
    v_pk_add_f32 v[28:29], v[60:61], v[64:65]
    v_pk_add_f32 v[30:31], v[62:63], v[66:67]
    s_waitcnt vmcnt(8)
    v_pk_add_f32 v[32:33], v[68:69], v[72:73]
    v_pk_add_f32 v[34:35], v[70:71], v[74:75]
    v_pk_add_f32 v[28:29], v[28:29], v[32:33]
    v_pk_add_f32 v[30:31], v[30:31], v[34:35]
    v_pk_add_f32 v[20:21], v[20:21], v[28:29]
    v_pk_add_f32 v[22:23], v[22:23], v[30:31]
    v_pk_add_f32 v[36:37], v[20:21], v[22:23]
    v_cmp_u_f32 vcc, v36, v37
    s_cbranch_vccz L_x2w
    v_max_u32 v36, v44, v45
    v_max3_u32 v36, v46, v47, v36
    v_max3_u32 v36, v48, v49, v36
    v_max3_u32 v36, v50, v51, v36
    v_max3_u32 v36, v52, v53, v36
    v_max3_u32 v36, v54, v55, v36
    v_max3_u32 v36, v56, v57, v36
    v_max3_u32 v36, v58, v59, v36
    v_max3_u32 v36, v60, v61, v36
    v_max3_u32 v36, v62, v63, v36
    v_max3_u32 v36, v64, v65, v36
    v_max3_u32 v36, v66, v67, v36
    v_max3_u32 v36, v68, v69, v36
    v_max3_u32 v36, v70, v71, v36
    v_max3_u32 v36, v72, v73, v36
    v_max3_u32 v36, v74, v75, v36
    v_cmp_eq_u32 vcc, -1, v36
    s_cbranch_vccz L_x2w
    s_waitcnt vmcnt(0)
    s_sub_u32 s44, s44, 1
    s_cmp_eq_u32 s44, 0
    s_cbranch_scc1 L_exit
    s_branch L_x2
L_x2c:
    v_max_u32 v36, v76, v77
    v_max3_u32 v36, v78, v79, v36
    v_max3_u32 v36, v80, v81, v36
    v_max3_u32 v36, v82, v83, v36
    v_max3_u32 v36, v84, v85, v36
    v_max3_u32 v36, v86, v87, v36
    v_max3_u32 v36, v88, v89, v36
    v_max3_u32 v36, v90, v91, v36
    v_max3_u32 v36, v92, v93, v36
    v_max3_u32 v36, v94, v95, v36
    v_max3_u32 v36, v96, v97, v36
    v_max3_u32 v36, v98, v99, v36
    v_max3_u32 v36, v100, v101, v36
    v_max3_u32 v36, v102, v103, v36
    v_max3_u32 v36, v104, v105, v36
    v_max3_u32 v36, v106, v107, v36
    v_cmp_eq_u32 vcc, -1, v36
    s_cbranch_vccz L_x2ok
    s_sub_u32 s44, s44, 1
    s_cmp_eq_u32 s44, 0
    s_cbranch_scc1 L_exit
    global_load_dwordx4 v[76:79], v16, s[26:27] offset:2560 sc1
    global_load_dwordx4 v[80:83], v17, s[26:27] offset:-2560 sc1
    global_load_dwordx4 v[84:87], v17, s[26:27] offset:0 sc1
    global_load_dwordx4 v[88:91], v17, s[26:27] offset:2560 sc1
    global_load_dwordx4 v[92:95], v18, s[26:27] offset:-2560 sc1
    global_load_dwordx4 v[96:99], v18, s[26:27] offset:0 sc1
    global_load_dwordx4 v[100:103], v18, s[26:27] offset:2560 sc1
    global_load_dwordx4 v[104:107], v19, s[26:27] offset:-2560 sc1
L_x2w:
    s_waitcnt vmcnt(6)
    v_pk_add_f32 v[40:41], v[76:77], v[80:81]
    v_pk_add_f32 v[42:43], v[78:79], v[82:83]
    s_waitcnt vmcnt(4)
    v_pk_add_f32 v[24:25], v[84:85], v[88:89]
    v_pk_add_f32 v[26:27], v[86:87], v[90:91]
    v_pk_add_f32 v[40:41], v[40:41], v[24:25]
    v_pk_add_f32 v[42:43], v[42:43], v[26:27]
    s_waitcnt vmcnt(2)
    v_pk_add_f32 v[28:29], v[92:93], v[96:97]
    v_pk_add_f32 v[30:31], v[94:95], v[98:99]
    s_waitcnt vmcnt(0)
    v_pk_add_f32 v[32:33], v[100:101], v[104:105]
    v_pk_add_f32 v[34:35], v[102:103], v[106:107]
    v_pk_add_f32 v[28:29], v[28:29], v[32:33]
    v_pk_add_f32 v[30:31], v[30:31], v[34:35]
    v_pk_add_f32 v[40:41], v[40:41], v[28:29]
    v_pk_add_f32 v[42:43], v[42:43], v[30:31]
    v_pk_add_f32 v[40:41], v[40:41], v[20:21]
    v_pk_add_f32 v[42:43], v[42:43], v[22:23]
    v_pk_add_f32 v[36:37], v[40:41], v[42:43]
    v_cmp_u_f32 vcc, v36, v37
    s_cbranch_vccnz L_x2c
L_x2ok:
    v_cvt_pk_bf16_f32 v40, 0, v40
    v_cvt_pk_bf16_f32 v41, 0, v41
    v_cvt_pk_bf16_f32 v42, 0, v42
    v_cvt_pk_bf16_f32 v43, 0, v43
    v_pk_add_f32 v[40:41], v[40:41], v[244:245]
    v_pk_add_f32 v[42:43], v[42:43], v[246:247]
    v_cvt_pk_bf16_f32 v40, 0, v40
    v_cvt_pk_bf16_f32 v41, 0, v41
    v_cvt_pk_bf16_f32 v42, 0, v42
    v_cvt_pk_bf16_f32 v43, 0, v43
    ds_write_b128 v3, v[40:43] offset:30720
    v_pk_add_f32 v[24:25], v[40:41], v[42:43]
    v_pk_mul_f32 v[26:27], v[40:41], v[40:41]
    v_add_f32 v12, v24, v25
    v_fmac_f32 v26, v42, v42
    v_fmac_f32 v27, v43, v43
    v_add_f32 v13, v26, v27
    s_cmp_lg_u32 s71, 0
    s_cbranch_scc1 L_noh
    global_store_dwordx4 v6, v[40:43], s[26:27] sc1
L_noh:
    s_mov_b64 exec, -1
    v_add_f32_dpp v12, v12, v12 quad_perm:[1,0,3,2] row_mask:0xf bank_mask:0xf
    v_add_f32_dpp v13, v13, v13 quad_perm:[1,0,3,2] row_mask:0xf bank_mask:0xf
    s_nop 0
    v_add_f32_dpp v12, v12, v12 quad_perm:[2,3,0,1] row_mask:0xf bank_mask:0xf
    v_add_f32_dpp v13, v13, v13 quad_perm:[2,3,0,1] row_mask:0xf bank_mask:0xf
    s_nop 0
    v_add_f32_dpp v12, v12, v12 row_half_mirror row_mask:0xf bank_mask:0xf
    v_add_f32_dpp v13, v13, v13 row_half_mirror row_mask:0xf bank_mask:0xf
    s_nop 0
    v_add_f32_dpp v12, v12, v12 row_mirror row_mask:0xf bank_mask:0xf
    v_add_f32_dpp v13, v13, v13 row_mirror row_mask:0xf bank_mask:0xf
    s_nop 0
    v_add_f32_dpp v12, v12, v12 row_bcast:15 row_mask:0xa bank_mask:0xf
    v_add_f32_dpp v13, v13, v13 row_bcast:15 row_mask:0xa bank_mask:0xf
    s_nop 0
    v_add_f32_dpp v12, v12, v12 row_bcast:31 row_mask:0xc bank_mask:0xf
    v_add_f32_dpp v13, v13, v13 row_bcast:31 row_mask:0xc bank_mask:0xf
    s_mov_b32 exec_lo, 0
    s_mov_b32 exec_hi, 0x80000000
    ds_write_b64 v11, v[12:13] offset:64
    s_mov_b64 exec, -1
    s_waitcnt lgkmcnt(0)
    s_barrier
    ds_read_b128 v[56:59], v10 offset:64
    ds_read_b128 v[60:63], v10 offset:80
    ds_read2st64_b32 v[44:45], v4 offset0:0 offset1:1
    ds_read2st64_b32 v[46:47], v4 offset0:2 offset1:3
    ds_read2st64_b32 v[48:49], v4 offset0:4 offset1:5
    ds_read2st64_b32 v[50:51], v4 offset0:6 offset1:7
    ds_read2st64_b32 v[52:53], v4 offset0:8 offset1:9
    s_waitcnt lgkmcnt(5)
    v_pk_add_f32 v[56:57], v[56:57], v[58:59]
    v_pk_add_f32 v[60:61], v[60:61], v[62:63]
    v_pk_add_f32 v[56:57], v[56:57], v[60:61]
    v_mul_f32 v56, v56, v248
    v_mul_f32 v57, v57, v248
    v_fma_f32 v57, -v56, v56, v57
    v_cvt_pk_bf16_f32 v58, 0, -v56
    v_max_f32 v57, 0, v57
    v_cvt_pk_bf16_f32 v57, 0, v57
    v_add_f32 v57, 0x3727c5ac, v57
    v_cvt_pk_bf16_f32 v57, 0, v57
    v_sqrt_f32 v57, v57
    v_mov_b32 v59, v58
    v_cvt_pk_bf16_f32 v57, 0, v57
    v_rcp_f32 v60, v57
    s_waitcnt lgkmcnt(0)
    v_pk_add_f32 v[44:45], v[44:45], v[58:59]
    v_pk_add_f32 v[46:47], v[46:47], v[58:59]
    v_pk_add_f32 v[48:49], v[48:49], v[58:59]
    v_pk_add_f32 v[50:51], v[50:51], v[58:59]
    v_pk_add_f32 v[52:53], v[52:53], v[58:59]
    v_fma_f32 v62, -v57, v60, 1.0
    v_fma_f32 v60, v62, v60, v60
    v_cvt_pk_bf16_f32 v44, 0, v44
    v_cvt_pk_bf16_f32 v45, 0, v45
    v_cvt_pk_bf16_f32 v46, 0, v46
    v_cvt_pk_bf16_f32 v47, 0, v47
    v_cvt_pk_bf16_f32 v48, 0, v48
    v_cvt_pk_bf16_f32 v49, 0, v49
    v_cvt_pk_bf16_f32 v50, 0, v50
    v_cvt_pk_bf16_f32 v51, 0, v51
    v_cvt_pk_bf16_f32 v52, 0, v52
    v_cvt_pk_bf16_f32 v53, 0, v53
    v_mov_b32 v61, v60
    v_pk_mul_f32 v[44:45], v[44:45], v[60:61]
    v_pk_mul_f32 v[46:47], v[46:47], v[60:61]
    v_pk_mul_f32 v[48:49], v[48:49], v[60:61]
    v_pk_mul_f32 v[50:51], v[50:51], v[60:61]
    v_pk_mul_f32 v[52:53], v[52:53], v[60:61]
    v_cvt_pk_bf16_f32 v44, v44, v45
    v_cvt_pk_bf16_f32 v45, v46, v47
    v_cvt_pk_bf16_f32 v46, v48, v49
    v_cvt_pk_bf16_f32 v47, v50, v51
    v_cvt_pk_bf16_f32 v48, v52, v53
    v_dot2_f32_bf16 v24, v108, v44, 0
    v_dot2_f32_bf16 v25, v109, v44, 0
    v_dot2_f32_bf16 v26, v110, v44, 0
    v_dot2_f32_bf16 v27, v111, v44, 0
    v_dot2_f32_bf16 v28, v112, v44, 0
    v_dot2_f32_bf16 v29, v113, v44, 0
    v_dot2_f32_bf16 v30, v114, v44, 0
    v_dot2_f32_bf16 v31, v115, v44, 0
    v_dot2_f32_bf16 v32, v116, v44, 0
    v_dot2_f32_bf16 v33, v117, v44, 0
    v_dot2_f32_bf16 v34, v118, v44, 0
    v_dot2_f32_bf16 v35, v119, v44, 0
    v_dot2_f32_bf16 v36, v120, v44, 0
    v_dot2_f32_bf16 v37, v121, v44, 0
    v_dot2_f32_bf16 v38, v122, v44, 0
    v_dot2_f32_bf16 v39, v123, v44, 0
    v_dot2c_f32_bf16 v24, v124, v45
    v_dot2c_f32_bf16 v25, v125, v45
    v_dot2c_f32_bf16 v26, v126, v45
    v_dot2c_f32_bf16 v27, v127, v45
    v_dot2c_f32_bf16 v28, v128, v45
    v_dot2c_f32_bf16 v29, v129, v45
    v_dot2c_f32_bf16 v30, v130, v45
    v_dot2c_f32_bf16 v31, v131, v45
    v_dot2c_f32_bf16 v32, v132, v45
    v_dot2c_f32_bf16 v33, v133, v45
    v_dot2c_f32_bf16 v34, v134, v45
    v_dot2c_f32_bf16 v35, v135, v45
    v_dot2c_f32_bf16 v36, v136, v45
    v_dot2c_f32_bf16 v37, v137, v45
    v_dot2c_f32_bf16 v38, v138, v45
    v_dot2c_f32_bf16 v39, v139, v45
    v_dot2c_f32_bf16 v24, v140, v46
    v_dot2c_f32_bf16 v25, v141, v46
    v_dot2c_f32_bf16 v26, v142, v46
    v_dot2c_f32_bf16 v27, v143, v46
    v_dot2c_f32_bf16 v28, v144, v46
    v_dot2c_f32_bf16 v29, v145, v46
    v_dot2c_f32_bf16 v30, v146, v46
    v_dot2c_f32_bf16 v31, v147, v46
    v_dot2c_f32_bf16 v32, v148, v46
    v_dot2c_f32_bf16 v33, v149, v46
    v_dot2c_f32_bf16 v34, v150, v46
    v_dot2c_f32_bf16 v35, v151, v46
    v_dot2c_f32_bf16 v36, v152, v46
    v_dot2c_f32_bf16 v37, v153, v46
    v_dot2c_f32_bf16 v38, v154, v46
    v_dot2c_f32_bf16 v39, v155, v46
    v_dot2c_f32_bf16 v24, v156, v47
    v_dot2c_f32_bf16 v25, v157, v47
    v_dot2c_f32_bf16 v26, v158, v47
    v_dot2c_f32_bf16 v27, v159, v47
    v_dot2c_f32_bf16 v28, v160, v47
    v_dot2c_f32_bf16 v29, v161, v47
    v_dot2c_f32_bf16 v30, v162, v47
    v_dot2c_f32_bf16 v31, v163, v47
    v_dot2c_f32_bf16 v32, v164, v47
    v_dot2c_f32_bf16 v33, v165, v47
    v_dot2c_f32_bf16 v34, v166, v47
    v_dot2c_f32_bf16 v35, v167, v47
    v_dot2c_f32_bf16 v36, v168, v47
    v_dot2c_f32_bf16 v37, v169, v47
    v_dot2c_f32_bf16 v38, v170, v47
    v_dot2c_f32_bf16 v39, v171, v47
    v_dot2c_f32_bf16 v24, v172, v48
    v_dot2c_f32_bf16 v25, v173, v48
    v_dot2c_f32_bf16 v26, v174, v48
    v_dot2c_f32_bf16 v27, v175, v48
    v_dot2c_f32_bf16 v28, v176, v48
    v_dot2c_f32_bf16 v29, v177, v48
    v_dot2c_f32_bf16 v30, v178, v48
    v_dot2c_f32_bf16 v31, v179, v48
    v_dot2c_f32_bf16 v32, v180, v48
    v_dot2c_f32_bf16 v33, v181, v48
    v_dot2c_f32_bf16 v34, v182, v48
    v_dot2c_f32_bf16 v35, v183, v48
    v_dot2c_f32_bf16 v36, v184, v48
    v_dot2c_f32_bf16 v37, v185, v48
    v_dot2c_f32_bf16 v38, v186, v48
    v_dot2c_f32_bf16 v39, v187, v48
    v_permlane32_swap_b32 v24, v28
    v_permlane32_swap_b32 v25, v29
    v_permlane32_swap_b32 v26, v30
    v_permlane32_swap_b32 v27, v31
    v_permlane32_swap_b32 v32, v36
    v_permlane32_swap_b32 v33, v37
    v_permlane32_swap_b32 v34, v38
    v_permlane32_swap_b32 v35, v39
    v_pk_add_f32 v[24:25], v[24:25], v[28:29]
    v_pk_add_f32 v[26:27], v[26:27], v[30:31]
    v_pk_add_f32 v[32:33], v[32:33], v[36:37]
    v_pk_add_f32 v[34:35], v[34:35], v[38:39]
    v_permlane16_swap_b32 v24, v26
    v_permlane16_swap_b32 v25, v27
    v_permlane16_swap_b32 v32, v34
    v_permlane16_swap_b32 v33, v35
    v_pk_add_f32 v[24:25], v[24:25], v[26:27]
    v_pk_add_f32 v[32:33], v[32:33], v[34:35]
    s_nop 0
    v_add_f32_dpp v12, v24, v24 row_ror:8 row_mask:0xf bank_mask:0x3
    v_add_f32_dpp v13, v32, v32 row_ror:8 row_mask:0xf bank_mask:0x3
    s_nop 0
    v_add_f32_dpp v12, v25, v25 row_ror:8 row_mask:0xf bank_mask:0xc
    v_add_f32_dpp v13, v33, v33 row_ror:8 row_mask:0xf bank_mask:0xc
    s_nop 0
    v_add_f32_dpp v12, v12, v12 quad_perm:[1,0,3,2] row_mask:0xf bank_mask:0xf
    v_add_f32_dpp v13, v13, v13 quad_perm:[1,0,3,2] row_mask:0xf bank_mask:0xf
    s_nop 0
    v_add_f32_dpp v12, v12, v12 quad_perm:[2,3,0,1] row_mask:0xf bank_mask:0xf
    v_add_f32_dpp v13, v13, v13 quad_perm:[2,3,0,1] row_mask:0xf bank_mask:0xf
    s_nop 0
    v_add_f32_dpp v12, v12, v12 row_half_mirror row_mask:0xf bank_mask:0xf
    v_add_f32_dpp v13, v13, v13 row_half_mirror row_mask:0xf bank_mask:0xf
    v_cvt_pk_bf16_f32 v12, 0, v12
    v_cvt_pk_bf16_f32 v13, 0, v13
    v_mul_f32 v14, 0xbfb8aa3b, v12
    v_exp_f32 v14, v14
    s_nop 0
    v_add_f32 v14, 1.0, v14
    v_rcp_f32 v15, v14
    s_nop 0
    v_mul_f32 v12, v12, v15
    v_cvt_pk_bf16_f32 v12, 0, v12
    v_mul_f32 v12, v12, v13
    s_nop 1
    v_mov_b32_dpp v13, v12 row_ror:8 row_mask:0xf bank_mask:0xf
    v_cvt_pk_bf16_f32 v12, v12, v13
    s_nop 0
    v_readlane_b32 s54, v12, 0
    v_readlane_b32 s55, v12, 16
    v_readlane_b32 s56, v12, 32
    v_readlane_b32 s57, v12, 48
    v_dot2_f32_bf16 v188, s54, v204, 0
    v_dot2_f32_bf16 v189, s54, v205, 0
    v_dot2_f32_bf16 v190, s54, v206, 0
    v_dot2_f32_bf16 v191, s54, v207, 0
    v_dot2_f32_bf16 v192, s54, v208, 0
    v_dot2_f32_bf16 v193, s54, v209, 0
    v_dot2_f32_bf16 v194, s54, v210, 0
    v_dot2_f32_bf16 v195, s54, v211, 0
    v_dot2_f32_bf16 v196, s54, v212, 0
    v_dot2_f32_bf16 v197, s54, v213, 0
    v_dot2c_f32_bf16 v188, s55, v214
    v_dot2c_f32_bf16 v189, s55, v215
    v_dot2c_f32_bf16 v190, s55, v216
    v_dot2c_f32_bf16 v191, s55, v217
    v_dot2c_f32_bf16 v192, s55, v218
    v_dot2c_f32_bf16 v193, s55, v219
    v_dot2c_f32_bf16 v194, s55, v220
    v_dot2c_f32_bf16 v195, s55, v221
    v_dot2c_f32_bf16 v196, s55, v222
    v_dot2c_f32_bf16 v197, s55, v223
    v_dot2c_f32_bf16 v188, s56, v224
    v_dot2c_f32_bf16 v189, s56, v225
    v_dot2c_f32_bf16 v190, s56, v226
    v_dot2c_f32_bf16 v191, s56, v227
    v_dot2c_f32_bf16 v192, s56, v228
    v_dot2c_f32_bf16 v193, s56, v229
    v_dot2c_f32_bf16 v194, s56, v230
    v_dot2c_f32_bf16 v195, s56, v231
    v_dot2c_f32_bf16 v196, s56, v232
    v_dot2c_f32_bf16 v197, s56, v233
    v_dot2c_f32_bf16 v188, s57, v234
    v_dot2c_f32_bf16 v189, s57, v235
    v_dot2c_f32_bf16 v190, s57, v236
    v_dot2c_f32_bf16 v191, s57, v237
    v_dot2c_f32_bf16 v192, s57, v238
    v_dot2c_f32_bf16 v193, s57, v239
    v_dot2c_f32_bf16 v194, s57, v240
    v_dot2c_f32_bf16 v195, s57, v241
    v_dot2c_f32_bf16 v196, s57, v242
    v_dot2c_f32_bf16 v197, s57, v243
    ds_write_b128 v7, v[188:191]
    ds_write_b128 v7, v[192:195] offset:1024
    s_nop 0
    ds_write_b64 v8, v[196:197] offset:2048
    s_waitcnt lgkmcnt(0)
    s_barrier
    ds_read_b128 v[44:47], v9 offset:0
    ds_read_b128 v[48:51], v9 offset:2560
    ds_read_b128 v[52:55], v9 offset:5120
    ds_read_b128 v[56:59], v9 offset:7680
    s_waitcnt lgkmcnt(2)
    v_pk_add_f32 v[44:45], v[44:45], v[48:49]
    v_pk_add_f32 v[46:47], v[46:47], v[50:51]
    s_waitcnt lgkmcnt(0)
    v_pk_add_f32 v[52:53], v[52:53], v[56:57]
    v_pk_add_f32 v[54:55], v[54:55], v[58:59]
    v_pk_add_f32 v[44:45], v[44:45], v[52:53]
    v_pk_add_f32 v[46:47], v[46:47], v[54:55]
    v_min_u32 v44, -2, v44
    v_min_u32 v45, -2, v45
    v_min_u32 v46, -2, v46
    v_min_u32 v47, -2, v47
    s_mov_b32 exec_hi, 0xff
    global_store_dwordx4 v5, v[44:47], s[26:27] sc1
    s_branch L_fin
L_vlast:
    v_lshrrev_b32 v32, 16, v28
    v_lshrrev_b32 v33, 16, v29
    v_lshrrev_b32 v34, 16, v30
    v_lshrrev_b32 v35, 16, v31
    s_waitcnt vmcnt(8)
    buffer_load_dwordx4 v[96:99], v2, s[32:35], s36 offen offset:0 nt
    v_dot2c_f32_bf16 v36, v60, v32
    v_dot2c_f32_bf16 v37, v60, v28
    v_dot2c_f32_bf16 v38, v61, v32
    v_dot2c_f32_bf16 v39, v61, v28
    v_dot2c_f32_bf16 v40, v62, v32
    v_dot2c_f32_bf16 v41, v62, v28
    v_dot2c_f32_bf16 v42, v63, v32
    v_dot2c_f32_bf16 v43, v63, v28
    s_waitcnt vmcnt(8)
    buffer_load_dwordx4 v[100:103], v2, s[32:35], s36 offen offset:128 nt
    v_dot2c_f32_bf16 v44, v64, v32
    v_dot2c_f32_bf16 v45, v64, v28
    v_dot2c_f32_bf16 v46, v65, v32
    v_dot2c_f32_bf16 v47, v65, v28
    v_dot2c_f32_bf16 v48, v66, v32
    v_dot2c_f32_bf16 v49, v66, v28
    v_dot2c_f32_bf16 v50, v67, v32
    v_dot2c_f32_bf16 v51, v67, v28
    s_waitcnt vmcnt(8)
    buffer_load_dwordx4 v[104:107], v2, s[32:35], s36 offen offset:256 nt
    v_dot2c_f32_bf16 v52, v68, v32
    v_dot2c_f32_bf16 v53, v68, v28
    v_dot2c_f32_bf16 v54, v69, v32
    v_dot2c_f32_bf16 v55, v69, v28
    v_dot2c_f32_bf16 v56, v70, v32
    v_dot2c_f32_bf16 v57, v70, v28
    v_dot2c_f32_bf16 v58, v71, v32
    v_dot2c_f32_bf16 v59, v71, v28
    s_add_u32 s36, s36, 783360
    s_waitcnt vmcnt(8)
    v_dot2c_f32_bf16 v36, v72, v33
    v_dot2c_f32_bf16 v37, v72, v29
    v_dot2c_f32_bf16 v38, v73, v33
    v_dot2c_f32_bf16 v39, v73, v29
    v_dot2c_f32_bf16 v40, v74, v33
    v_dot2c_f32_bf16 v41, v74, v29
    v_dot2c_f32_bf16 v42, v75, v33
    v_dot2c_f32_bf16 v43, v75, v29
    s_waitcnt vmcnt(7)
    v_dot2c_f32_bf16 v44, v76, v33
    v_dot2c_f32_bf16 v45, v76, v29
    v_dot2c_f32_bf16 v46, v77, v33
    v_dot2c_f32_bf16 v47, v77, v29
    v_dot2c_f32_bf16 v48, v78, v33
    v_dot2c_f32_bf16 v49, v78, v29
    v_dot2c_f32_bf16 v50, v79, v33
    v_dot2c_f32_bf16 v51, v79, v29
    s_waitcnt vmcnt(6)
    v_dot2c_f32_bf16 v52, v80, v33
    v_dot2c_f32_bf16 v53, v80, v29
    v_dot2c_f32_bf16 v54, v81, v33
    v_dot2c_f32_bf16 v55, v81, v29
    v_dot2c_f32_bf16 v56, v82, v33
    v_dot2c_f32_bf16 v57, v82, v29
    v_dot2c_f32_bf16 v58, v83, v33
    v_dot2c_f32_bf16 v59, v83, v29
    s_waitcnt vmcnt(5)
    v_dot2c_f32_bf16 v36, v84, v34
    v_dot2c_f32_bf16 v37, v84, v30
    v_dot2c_f32_bf16 v38, v85, v34
    v_dot2c_f32_bf16 v39, v85, v30
    v_dot2c_f32_bf16 v40, v86, v34
    v_dot2c_f32_bf16 v41, v86, v30
    v_dot2c_f32_bf16 v42, v87, v34
    v_dot2c_f32_bf16 v43, v87, v30
    s_waitcnt vmcnt(4)
    v_dot2c_f32_bf16 v44, v88, v34
    v_dot2c_f32_bf16 v45, v88, v30
    v_dot2c_f32_bf16 v46, v89, v34
    v_dot2c_f32_bf16 v47, v89, v30
    v_dot2c_f32_bf16 v48, v90, v34
    v_dot2c_f32_bf16 v49, v90, v30
    v_dot2c_f32_bf16 v50, v91, v34
    v_dot2c_f32_bf16 v51, v91, v30
    s_waitcnt vmcnt(3)
    v_dot2c_f32_bf16 v52, v92, v34
    v_dot2c_f32_bf16 v53, v92, v30
    v_dot2c_f32_bf16 v54, v93, v34
    v_dot2c_f32_bf16 v55, v93, v30
    v_dot2c_f32_bf16 v56, v94, v34
    v_dot2c_f32_bf16 v57, v94, v30
    v_dot2c_f32_bf16 v58, v95, v34
    v_dot2c_f32_bf16 v59, v95, v30
    s_waitcnt vmcnt(2)
    v_dot2c_f32_bf16 v36, v96, v35
    v_dot2c_f32_bf16 v37, v96, v31
    v_dot2c_f32_bf16 v38, v97, v35
    v_dot2c_f32_bf16 v39, v97, v31
    v_dot2c_f32_bf16 v40, v98, v35
    v_dot2c_f32_bf16 v41, v98, v31
    v_dot2c_f32_bf16 v42, v99, v35
    v_dot2c_f32_bf16 v43, v99, v31
    s_waitcnt vmcnt(1)
    v_dot2c_f32_bf16 v44, v100, v35
    v_dot2c_f32_bf16 v45, v100, v31
    v_dot2c_f32_bf16 v46, v101, v35
    v_dot2c_f32_bf16 v47, v101, v31
    v_dot2c_f32_bf16 v48, v102, v35
    v_dot2c_f32_bf16 v49, v102, v31
    v_dot2c_f32_bf16 v50, v103, v35
    v_dot2c_f32_bf16 v51, v103, v31
    s_waitcnt vmcnt(0)
    v_dot2c_f32_bf16 v52, v104, v35
    v_dot2c_f32_bf16 v53, v104, v31
    v_dot2c_f32_bf16 v54, v105, v35
    v_dot2c_f32_bf16 v55, v105, v31
    v_dot2c_f32_bf16 v56, v106, v35
    v_dot2c_f32_bf16 v57, v106, v31
    v_dot2c_f32_bf16 v58, v107, v35
    v_dot2c_f32_bf16 v59, v107, v31
    s_mov_b32 s51, 64
    s_branch L_vhe
L_kd:
    s_waitcnt vmcnt(5)
    buffer_load_dwordx4 v[96:99], v2, s[32:35], s36 offen offset:0 nt
    v_dot2_f32_bf16 v24, v60, v12, 0
    v_dot2_f32_bf16 v24, v61, v13, v24
    v_dot2_f32_bf16 v24, v62, v14, v24
    v_dot2_f32_bf16 v24, v63, v15, v24
    ds_read_b32 v248, v249 offset:0
    v_mov_b32 v9, s51
    ds_write_b32 v5, v9 offset:0
    ds_read_b32 v7, v10 offset:56
    s_waitcnt vmcnt(5)
    buffer_load_dwordx4 v[100:103], v2, s[32:35], s36 offen offset:128 nt
    v_dot2_f32_bf16 v24, v64, v16, v24
    v_dot2_f32_bf16 v24, v65, v17, v24
    v_dot2_f32_bf16 v24, v66, v18, v24
    v_dot2_f32_bf16 v24, v67, v19, v24
    s_waitcnt vmcnt(5)
    buffer_load_dwordx4 v[104:107], v2, s[32:35], s36 offen offset:256 nt
    v_dot2_f32_bf16 v24, v68, v20, v24
    v_dot2_f32_bf16 v24, v69, v21, v24
    v_dot2_f32_bf16 v24, v70, v22, v24
    v_dot2_f32_bf16 v24, v71, v23, v24
    s_add_u32 s36, s36, 783360
    s_and_b32 s46, s51, 7
    s_cmp_eq_u32 s46, 7
    s_cselect_b32 s46, 88080384, 0
    s_add_u32 s36, s36, s46
    s_cmp_eq_u32 s51, 31
    s_cselect_b32 s32, s38, s32
    s_cselect_b32 s33, s39, s33
    s_cselect_b32 s36, s37, s36
    s_waitcnt vmcnt(5)
    buffer_load_dwordx4 v[60:63], v2, s[32:35], s36 offen offset:0 nt
    v_dot2_f32_bf16 v25, v72, v12, 0
    v_dot2_f32_bf16 v25, v73, v13, v25
    v_dot2_f32_bf16 v25, v74, v14, v25
    v_dot2_f32_bf16 v25, v75, v15, v25
    v_add_f32_dpp v24, v24, v24 quad_perm:[1,0,3,2] row_mask:0xf bank_mask:0xf
    s_waitcnt vmcnt(5)
    buffer_load_dwordx4 v[64:67], v2, s[32:35], s36 offen offset:128 nt
    v_dot2_f32_bf16 v25, v76, v16, v25
    v_dot2_f32_bf16 v25, v77, v17, v25
    v_dot2_f32_bf16 v25, v78, v18, v25
    v_dot2_f32_bf16 v25, v79, v19, v25
    v_add_f32_dpp v24, v24, v24 quad_perm:[2,3,0,1] row_mask:0xf bank_mask:0xf
    s_waitcnt vmcnt(5)
    buffer_load_dwordx4 v[68:71], v2, s[32:35], s36 offen offset:256 nt
    v_dot2_f32_bf16 v25, v80, v20, v25
    v_dot2_f32_bf16 v25, v81, v21, v25
    v_dot2_f32_bf16 v25, v82, v22, v25
    v_dot2_f32_bf16 v25, v83, v23, v25
    v_add_f32_dpp v24, v24, v24 row_half_mirror row_mask:0xf bank_mask:0xf
    s_add_u32 s36, s36, 3072
    s_waitcnt vmcnt(5)
    buffer_load_dwordx4 v[72:75], v2, s[32:35], s36 offen offset:0 nt
    v_dot2_f32_bf16 v26, v84, v12, 0
    v_dot2_f32_bf16 v26, v85, v13, v26
    v_dot2_f32_bf16 v26, v86, v14, v26
    v_dot2_f32_bf16 v26, v87, v15, v26
    v_add_f32_dpp v25, v25, v25 quad_perm:[1,0,3,2] row_mask:0xf bank_mask:0xf
    s_waitcnt lgkmcnt(0)
    v_readfirstlane_b32 s55, v7
    v_cmp_le_u32 vcc, s51, v248
    s_add_u32 s61, s51, 1
    s_and_b32 s61, s61, 7
    s_lshr_b32 s61, s55, s61
    s_and_b32 s47, vcc_lo, 15
    s_bcnt1_i32_b32 s47, s47
    s_waitcnt vmcnt(5)
    buffer_load_dwordx4 v[76:79], v2, s[32:35], s36 offen offset:128 nt
    v_dot2_f32_bf16 v26, v88, v16, v26
    v_dot2_f32_bf16 v26, v89, v17, v26
    v_dot2_f32_bf16 v26, v90, v18, v26
    v_dot2_f32_bf16 v26, v91, v19, v26
    v_add_f32_dpp v25, v25, v25 quad_perm:[2,3,0,1] row_mask:0xf bank_mask:0xf
    s_cmp_eq_u32 s47, 0
    s_cselect_b32 s59, -2, -1
    s_and_b32 s61, s61, s59
    s_cmp_ge_u32 s47, 3
    s_cselect_b32 s59, 0, 0x100
    s_and_b32 s59, s61, s59
    s_bitcmp1_b32 s61, 0
    s_cselect_b64 vcc, -1, 0
    s_waitcnt vmcnt(5)
    buffer_load_dwordx4 v[80:83], v2, s[32:35], s36 offen offset:256 nt
    v_dot2_f32_bf16 v26, v92, v20, v26
    v_dot2_f32_bf16 v26, v93, v21, v26
    v_dot2_f32_bf16 v26, v94, v22, v26
    v_dot2_f32_bf16 v26, v95, v23, v26
    v_add_f32_dpp v25, v25, v25 row_half_mirror row_mask:0xf bank_mask:0xf
    s_add_u32 s36, s36, 783360
    s_waitcnt vmcnt(5)
    buffer_load_dwordx4 v[84:87], v2, s[32:35], s36 offen offset:0 nt
    v_dot2_f32_bf16 v27, v96, v12, 0
    v_dot2_f32_bf16 v27, v97, v13, v27
    v_dot2_f32_bf16 v27, v98, v14, v27
    v_dot2_f32_bf16 v27, v99, v15, v27
    v_add_f32_dpp v26, v26, v26 quad_perm:[1,0,3,2] row_mask:0xf bank_mask:0xf
    s_waitcnt vmcnt(5)
    buffer_load_dwordx4 v[88:91], v2, s[32:35], s36 offen offset:128 nt
    v_dot2_f32_bf16 v27, v100, v16, v27
    v_dot2_f32_bf16 v27, v101, v17, v27
    v_dot2_f32_bf16 v27, v102, v18, v27
    v_dot2_f32_bf16 v27, v103, v19, v27
    v_add_f32_dpp v26, v26, v26 quad_perm:[2,3,0,1] row_mask:0xf bank_mask:0xf
    s_waitcnt vmcnt(5)
    buffer_load_dwordx4 v[92:95], v2, s[32:35], s36 offen offset:256 nt
    v_dot2_f32_bf16 v27, v104, v20, v27
    v_dot2_f32_bf16 v27, v105, v21, v27
    v_dot2_f32_bf16 v27, v106, v22, v27
    v_dot2_f32_bf16 v27, v107, v23, v27
    v_add_f32_dpp v26, v26, v26 row_half_mirror row_mask:0xf bank_mask:0xf
    s_add_u32 s36, s36, 3072
    s_nop 0
    s_branch L_ke
L_kl:
    s_waitcnt vmcnt(3)
    buffer_load_dwordx4 v[96:99], v2, s[32:35], s36 offen offset:0 nt
    v_dot2_f32_bf16 v24, v60, v12, 0
    v_dot2_f32_bf16 v24, v61, v13, v24
    v_dot2_f32_bf16 v24, v62, v14, v24
    v_dot2_f32_bf16 v24, v63, v15, v24
    ds_read_b32 v248, v249 offset:0
    v_mov_b32 v9, s51
    ds_write_b32 v5, v9 offset:0
    ds_read_b32 v7, v10 offset:56
    s_waitcnt vmcnt(3)
    buffer_load_dwordx4 v[100:103], v2, s[32:35], s36 offen offset:128 nt
    v_dot2_f32_bf16 v24, v64, v16, v24
    v_dot2_f32_bf16 v24, v65, v17, v24
    v_dot2_f32_bf16 v24, v66, v18, v24
    v_dot2_f32_bf16 v24, v67, v19, v24
    s_waitcnt vmcnt(3)
    buffer_load_dwordx4 v[104:107], v2, s[32:35], s36 offen offset:256 nt
    v_dot2_f32_bf16 v24, v68, v20, v24
    v_dot2_f32_bf16 v24, v69, v21, v24
    v_dot2_f32_bf16 v24, v70, v22, v24
    v_dot2_f32_bf16 v24, v71, v23, v24
    s_add_u32 s36, s36, 783360
    s_and_b32 s46, s51, 7
    s_cmp_eq_u32 s46, 7
    s_cselect_b32 s46, 88080384, 0
    s_add_u32 s36, s36, s46
    s_cmp_eq_u32 s51, 31
    s_cselect_b32 s32, s38, s32
    s_cselect_b32 s33, s39, s33
    s_cselect_b32 s36, s37, s36
    s_waitcnt vmcnt(3)
    buffer_load_dwordx4 v[60:63], v2, s[32:35], s36 offen offset:0 nt
    v_dot2_f32_bf16 v25, v72, v12, 0
    v_dot2_f32_bf16 v25, v73, v13, v25
    v_dot2_f32_bf16 v25, v74, v14, v25
    v_dot2_f32_bf16 v25, v75, v15, v25
    v_add_f32_dpp v24, v24, v24 quad_perm:[1,0,3,2] row_mask:0xf bank_mask:0xf
    s_waitcnt vmcnt(3)
    buffer_load_dwordx4 v[64:67], v2, s[32:35], s36 offen offset:128 nt
    v_dot2_f32_bf16 v25, v76, v16, v25
    v_dot2_f32_bf16 v25, v77, v17, v25
    v_dot2_f32_bf16 v25, v78, v18, v25
    v_dot2_f32_bf16 v25, v79, v19, v25
    v_add_f32_dpp v24, v24, v24 quad_perm:[2,3,0,1] row_mask:0xf bank_mask:0xf
    s_waitcnt vmcnt(3)
    buffer_load_dwordx4 v[68:71], v2, s[32:35], s36 offen offset:256 nt
    v_dot2_f32_bf16 v25, v80, v20, v25
    v_dot2_f32_bf16 v25, v81, v21, v25
    v_dot2_f32_bf16 v25, v82, v22, v25
    v_dot2_f32_bf16 v25, v83, v23, v25
    v_add_f32_dpp v24, v24, v24 row_half_mirror row_mask:0xf bank_mask:0xf
    s_add_u32 s36, s36, 3072
    s_waitcnt vmcnt(3)
    buffer_load_dwordx4 v[72:75], v2, s[32:35], s36 offen offset:0 nt
    v_dot2_f32_bf16 v26, v84, v12, 0
    v_dot2_f32_bf16 v26, v85, v13, v26
    v_dot2_f32_bf16 v26, v86, v14, v26
    v_dot2_f32_bf16 v26, v87, v15, v26
    v_add_f32_dpp v25, v25, v25 quad_perm:[1,0,3,2] row_mask:0xf bank_mask:0xf
    s_waitcnt lgkmcnt(0)
    v_readfirstlane_b32 s55, v7
    v_cmp_le_u32 vcc, s51, v248
    s_add_u32 s61, s51, 1
    s_and_b32 s61, s61, 7
    s_lshr_b32 s61, s55, s61
    s_and_b32 s47, vcc_lo, 15
    s_bcnt1_i32_b32 s47, s47
    s_waitcnt vmcnt(3)
    buffer_load_dwordx4 v[76:79], v2, s[32:35], s36 offen offset:128 nt
    v_dot2_f32_bf16 v26, v88, v16, v26
    v_dot2_f32_bf16 v26, v89, v17, v26
    v_dot2_f32_bf16 v26, v90, v18, v26
    v_dot2_f32_bf16 v26, v91, v19, v26
    v_add_f32_dpp v25, v25, v25 quad_perm:[2,3,0,1] row_mask:0xf bank_mask:0xf
    s_cmp_eq_u32 s47, 0
    s_cselect_b32 s59, -2, -1
    s_and_b32 s61, s61, s59
    s_cmp_ge_u32 s47, 3
    s_cselect_b32 s59, 0, 0x100
    s_and_b32 s59, s61, s59
    s_bitcmp1_b32 s61, 0
    s_cselect_b64 vcc, -1, 0
    s_waitcnt vmcnt(3)
    buffer_load_dwordx4 v[80:83], v2, s[32:35], s36 offen offset:256 nt
    v_dot2_f32_bf16 v26, v92, v20, v26
    v_dot2_f32_bf16 v26, v93, v21, v26
    v_dot2_f32_bf16 v26, v94, v22, v26
    v_dot2_f32_bf16 v26, v95, v23, v26
    v_add_f32_dpp v25, v25, v25 row_half_mirror row_mask:0xf bank_mask:0xf
    s_add_u32 s36, s36, 783360
    s_waitcnt vmcnt(3)
    buffer_load_dwordx4 v[84:87], v2, s[32:35], s36 offen offset:0 nt
    v_dot2_f32_bf16 v27, v96, v12, 0
    v_dot2_f32_bf16 v27, v97, v13, v27
    v_dot2_f32_bf16 v27, v98, v14, v27
    v_dot2_f32_bf16 v27, v99, v15, v27
    v_add_f32_dpp v26, v26, v26 quad_perm:[1,0,3,2] row_mask:0xf bank_mask:0xf
    s_waitcnt vmcnt(3)
    buffer_load_dwordx4 v[88:91], v2, s[32:35], s36 offen offset:128 nt
    v_dot2_f32_bf16 v27, v100, v16, v27
    v_dot2_f32_bf16 v27, v101, v17, v27
    v_dot2_f32_bf16 v27, v102, v18, v27
    v_dot2_f32_bf16 v27, v103, v19, v27
    v_add_f32_dpp v26, v26, v26 quad_perm:[2,3,0,1] row_mask:0xf bank_mask:0xf
    s_waitcnt vmcnt(3)
    buffer_load_dwordx4 v[92:95], v2, s[32:35], s36 offen offset:256 nt
    v_dot2_f32_bf16 v27, v104, v20, v27
    v_dot2_f32_bf16 v27, v105, v21, v27
    v_dot2_f32_bf16 v27, v106, v22, v27
    v_dot2_f32_bf16 v27, v107, v23, v27
    v_add_f32_dpp v26, v26, v26 row_half_mirror row_mask:0xf bank_mask:0xf
    s_add_u32 s36, s36, 3072
    s_nop 0
    s_branch L_ke
L_vd:
    s_waitcnt vmcnt(5)
    buffer_load_dwordx4 v[96:99], v2, s[32:35], s36 offen offset:0 nt
    v_lshrrev_b32 v32, 16, v28
    v_dot2c_f32_bf16 v36, v60, v32
    v_dot2c_f32_bf16 v37, v60, v28
    v_dot2c_f32_bf16 v38, v61, v32
    v_dot2c_f32_bf16 v39, v61, v28
    v_dot2c_f32_bf16 v40, v62, v32
    v_dot2c_f32_bf16 v41, v62, v28
    v_dot2c_f32_bf16 v42, v63, v32
    v_dot2c_f32_bf16 v43, v63, v28
    ds_read_b32 v248, v249 offset:0
    v_mov_b32 v9, s51
    ds_write_b32 v5, v9 offset:0
    ds_read_b32 v7, v10 offset:56
    s_waitcnt vmcnt(5)
    buffer_load_dwordx4 v[100:103], v2, s[32:35], s36 offen offset:128 nt
    v_dot2c_f32_bf16 v44, v64, v32
    v_dot2c_f32_bf16 v45, v64, v28
    v_dot2c_f32_bf16 v46, v65, v32
    v_dot2c_f32_bf16 v47, v65, v28
    v_dot2c_f32_bf16 v48, v66, v32
    v_dot2c_f32_bf16 v49, v66, v28
    v_dot2c_f32_bf16 v50, v67, v32
    v_dot2c_f32_bf16 v51, v67, v28
    s_waitcnt vmcnt(5)
    buffer_load_dwordx4 v[104:107], v2, s[32:35], s36 offen offset:256 nt
    v_dot2c_f32_bf16 v52, v68, v32
    v_dot2c_f32_bf16 v53, v68, v28
    v_dot2c_f32_bf16 v54, v69, v32
    v_dot2c_f32_bf16 v55, v69, v28
    v_dot2c_f32_bf16 v56, v70, v32
    v_dot2c_f32_bf16 v57, v70, v28
    v_dot2c_f32_bf16 v58, v71, v32
    v_dot2c_f32_bf16 v59, v71, v28
    s_add_u32 s36, s36, 783360
    s_and_b32 s46, s51, 7
    s_cmp_eq_u32 s46, 7
    s_cselect_b32 s46, 88080384, 0
    s_add_u32 s36, s36, s46
    s_waitcnt vmcnt(5)
    buffer_load_dwordx4 v[60:63], v2, s[32:35], s36 offen offset:0 nt
    v_lshrrev_b32 v33, 16, v29
    v_dot2c_f32_bf16 v36, v72, v33
    v_dot2c_f32_bf16 v37, v72, v29
    v_dot2c_f32_bf16 v38, v73, v33
    v_dot2c_f32_bf16 v39, v73, v29
    v_dot2c_f32_bf16 v40, v74, v33
    v_dot2c_f32_bf16 v41, v74, v29
    v_dot2c_f32_bf16 v42, v75, v33
    v_dot2c_f32_bf16 v43, v75, v29
    s_waitcnt vmcnt(5)
    buffer_load_dwordx4 v[64:67], v2, s[32:35], s36 offen offset:128 nt
    v_dot2c_f32_bf16 v44, v76, v33
    v_dot2c_f32_bf16 v45, v76, v29
    v_dot2c_f32_bf16 v46, v77, v33
    v_dot2c_f32_bf16 v47, v77, v29
    v_dot2c_f32_bf16 v48, v78, v33
    v_dot2c_f32_bf16 v49, v78, v29
    v_dot2c_f32_bf16 v50, v79, v33
    v_dot2c_f32_bf16 v51, v79, v29
    s_waitcnt vmcnt(5)
    buffer_load_dwordx4 v[68:71], v2, s[32:35], s36 offen offset:256 nt
    v_dot2c_f32_bf16 v52, v80, v33
    v_dot2c_f32_bf16 v53, v80, v29
    v_dot2c_f32_bf16 v54, v81, v33
    v_dot2c_f32_bf16 v55, v81, v29
    v_dot2c_f32_bf16 v56, v82, v33
    v_dot2c_f32_bf16 v57, v82, v29
    v_dot2c_f32_bf16 v58, v83, v33
    v_dot2c_f32_bf16 v59, v83, v29
    s_add_u32 s36, s36, 3072
    s_waitcnt vmcnt(5)
    buffer_load_dwordx4 v[72:75], v2, s[32:35], s36 offen offset:0 nt
    v_lshrrev_b32 v34, 16, v30
    v_dot2c_f32_bf16 v36, v84, v34
    v_dot2c_f32_bf16 v37, v84, v30
    v_dot2c_f32_bf16 v38, v85, v34
    v_dot2c_f32_bf16 v39, v85, v30
    v_dot2c_f32_bf16 v40, v86, v34
    v_dot2c_f32_bf16 v41, v86, v30
    v_dot2c_f32_bf16 v42, v87, v34
    v_dot2c_f32_bf16 v43, v87, v30
    s_waitcnt lgkmcnt(0)
    v_readfirstlane_b32 s55, v7
    v_cmp_le_u32 vcc, s51, v248
    s_add_u32 s61, s51, 1
    s_and_b32 s61, s61, 7
    s_lshr_b32 s61, s55, s61
    s_and_b32 s47, vcc_lo, 15
    s_bcnt1_i32_b32 s47, s47
    s_waitcnt vmcnt(5)
    buffer_load_dwordx4 v[76:79], v2, s[32:35], s36 offen offset:128 nt
    v_dot2c_f32_bf16 v44, v88, v34
    v_dot2c_f32_bf16 v45, v88, v30
    v_dot2c_f32_bf16 v46, v89, v34
    v_dot2c_f32_bf16 v47, v89, v30
    v_dot2c_f32_bf16 v48, v90, v34
    v_dot2c_f32_bf16 v49, v90, v30
    v_dot2c_f32_bf16 v50, v91, v34
    v_dot2c_f32_bf16 v51, v91, v30
    s_cmp_eq_u32 s47, 0
    s_cselect_b32 s59, -2, -1
    s_and_b32 s61, s61, s59
    s_cmp_ge_u32 s47, 3
    s_cselect_b32 s59, 0, 0x100
    s_and_b32 s59, s61, s59
    s_bitcmp1_b32 s61, 0
    s_cselect_b64 vcc, -1, 0
    s_waitcnt vmcnt(5)
    buffer_load_dwordx4 v[80:83], v2, s[32:35], s36 offen offset:256 nt
    v_dot2c_f32_bf16 v52, v92, v34
    v_dot2c_f32_bf16 v53, v92, v30
    v_dot2c_f32_bf16 v54, v93, v34
    v_dot2c_f32_bf16 v55, v93, v30
    v_dot2c_f32_bf16 v56, v94, v34
    v_dot2c_f32_bf16 v57, v94, v30
    v_dot2c_f32_bf16 v58, v95, v34
    v_dot2c_f32_bf16 v59, v95, v30
    s_add_u32 s36, s36, 783360
    s_waitcnt vmcnt(5)
    buffer_load_dwordx4 v[84:87], v2, s[32:35], s36 offen offset:0 nt
    v_lshrrev_b32 v35, 16, v31
    v_mov_b32 v27, v31
    v_add_u32 v3, 128, v3
    ds_read_b128 v[28:31], v3 offset:2048
    v_dot2c_f32_bf16 v36, v96, v35
    v_dot2c_f32_bf16 v37, v96, v27
    v_dot2c_f32_bf16 v38, v97, v35
    v_dot2c_f32_bf16 v39, v97, v27
    v_dot2c_f32_bf16 v40, v98, v35
    v_dot2c_f32_bf16 v41, v98, v27
    v_dot2c_f32_bf16 v42, v99, v35
    v_dot2c_f32_bf16 v43, v99, v27
    s_waitcnt vmcnt(5)
    buffer_load_dwordx4 v[88:91], v2, s[32:35], s36 offen offset:128 nt
    v_dot2c_f32_bf16 v44, v100, v35
    v_dot2c_f32_bf16 v45, v100, v27
    v_dot2c_f32_bf16 v46, v101, v35
    v_dot2c_f32_bf16 v47, v101, v27
    v_dot2c_f32_bf16 v48, v102, v35
    v_dot2c_f32_bf16 v49, v102, v27
    v_dot2c_f32_bf16 v50, v103, v35
    v_dot2c_f32_bf16 v51, v103, v27
    s_waitcnt vmcnt(5)
    buffer_load_dwordx4 v[92:95], v2, s[32:35], s36 offen offset:256 nt
    v_dot2c_f32_bf16 v52, v104, v35
    v_dot2c_f32_bf16 v53, v104, v27
    v_dot2c_f32_bf16 v54, v105, v35
    v_dot2c_f32_bf16 v55, v105, v27
    v_dot2c_f32_bf16 v56, v106, v35
    v_dot2c_f32_bf16 v57, v106, v27
    v_dot2c_f32_bf16 v58, v107, v35
    v_dot2c_f32_bf16 v59, v107, v27
    s_add_u32 s36, s36, 3072
    s_nop 0
    s_branch L_ve
L_vl:
    s_waitcnt vmcnt(3)
    buffer_load_dwordx4 v[96:99], v2, s[32:35], s36 offen offset:0 nt
    v_lshrrev_b32 v32, 16, v28
    v_dot2c_f32_bf16 v36, v60, v32
    v_dot2c_f32_bf16 v37, v60, v28
    v_dot2c_f32_bf16 v38, v61, v32
    v_dot2c_f32_bf16 v39, v61, v28
    v_dot2c_f32_bf16 v40, v62, v32
    v_dot2c_f32_bf16 v41, v62, v28
    v_dot2c_f32_bf16 v42, v63, v32
    v_dot2c_f32_bf16 v43, v63, v28
    ds_read_b32 v248, v249 offset:0
    v_mov_b32 v9, s51
    ds_write_b32 v5, v9 offset:0
    ds_read_b32 v7, v10 offset:56
    s_waitcnt vmcnt(3)
    buffer_load_dwordx4 v[100:103], v2, s[32:35], s36 offen offset:128 nt
    v_dot2c_f32_bf16 v44, v64, v32
    v_dot2c_f32_bf16 v45, v64, v28
    v_dot2c_f32_bf16 v46, v65, v32
    v_dot2c_f32_bf16 v47, v65, v28
    v_dot2c_f32_bf16 v48, v66, v32
    v_dot2c_f32_bf16 v49, v66, v28
    v_dot2c_f32_bf16 v50, v67, v32
    v_dot2c_f32_bf16 v51, v67, v28
    s_waitcnt vmcnt(3)
    buffer_load_dwordx4 v[104:107], v2, s[32:35], s36 offen offset:256 nt
    v_dot2c_f32_bf16 v52, v68, v32
    v_dot2c_f32_bf16 v53, v68, v28
    v_dot2c_f32_bf16 v54, v69, v32
    v_dot2c_f32_bf16 v55, v69, v28
    v_dot2c_f32_bf16 v56, v70, v32
    v_dot2c_f32_bf16 v57, v70, v28
    v_dot2c_f32_bf16 v58, v71, v32
    v_dot2c_f32_bf16 v59, v71, v28
    s_add_u32 s36, s36, 783360
    s_and_b32 s46, s51, 7
    s_cmp_eq_u32 s46, 7
    s_cselect_b32 s46, 88080384, 0
    s_add_u32 s36, s36, s46
    s_waitcnt vmcnt(3)
    buffer_load_dwordx4 v[60:63], v2, s[32:35], s36 offen offset:0 nt
    v_lshrrev_b32 v33, 16, v29
    v_dot2c_f32_bf16 v36, v72, v33
    v_dot2c_f32_bf16 v37, v72, v29
    v_dot2c_f32_bf16 v38, v73, v33
    v_dot2c_f32_bf16 v39, v73, v29
    v_dot2c_f32_bf16 v40, v74, v33
    v_dot2c_f32_bf16 v41, v74, v29
    v_dot2c_f32_bf16 v42, v75, v33
    v_dot2c_f32_bf16 v43, v75, v29
    s_waitcnt vmcnt(3)
    buffer_load_dwordx4 v[64:67], v2, s[32:35], s36 offen offset:128 nt
    v_dot2c_f32_bf16 v44, v76, v33
    v_dot2c_f32_bf16 v45, v76, v29
    v_dot2c_f32_bf16 v46, v77, v33
    v_dot2c_f32_bf16 v47, v77, v29
    v_dot2c_f32_bf16 v48, v78, v33
    v_dot2c_f32_bf16 v49, v78, v29
    v_dot2c_f32_bf16 v50, v79, v33
    v_dot2c_f32_bf16 v51, v79, v29
    s_waitcnt vmcnt(3)
    buffer_load_dwordx4 v[68:71], v2, s[32:35], s36 offen offset:256 nt
    v_dot2c_f32_bf16 v52, v80, v33
    v_dot2c_f32_bf16 v53, v80, v29
    v_dot2c_f32_bf16 v54, v81, v33
    v_dot2c_f32_bf16 v55, v81, v29
    v_dot2c_f32_bf16 v56, v82, v33
    v_dot2c_f32_bf16 v57, v82, v29
    v_dot2c_f32_bf16 v58, v83, v33
    v_dot2c_f32_bf16 v59, v83, v29
    s_add_u32 s36, s36, 3072
    s_waitcnt vmcnt(3)
    buffer_load_dwordx4 v[72:75], v2, s[32:35], s36 offen offset:0 nt
    v_lshrrev_b32 v34, 16, v30
    v_dot2c_f32_bf16 v36, v84, v34
    v_dot2c_f32_bf16 v37, v84, v30
    v_dot2c_f32_bf16 v38, v85, v34
    v_dot2c_f32_bf16 v39, v85, v30
    v_dot2c_f32_bf16 v40, v86, v34
    v_dot2c_f32_bf16 v41, v86, v30
    v_dot2c_f32_bf16 v42, v87, v34
    v_dot2c_f32_bf16 v43, v87, v30
    s_waitcnt lgkmcnt(0)
    v_readfirstlane_b32 s55, v7
    v_cmp_le_u32 vcc, s51, v248
    s_add_u32 s61, s51, 1
    s_and_b32 s61, s61, 7
    s_lshr_b32 s61, s55, s61
    s_and_b32 s47, vcc_lo, 15
    s_bcnt1_i32_b32 s47, s47
    s_waitcnt vmcnt(3)
    buffer_load_dwordx4 v[76:79], v2, s[32:35], s36 offen offset:128 nt
    v_dot2c_f32_bf16 v44, v88, v34
    v_dot2c_f32_bf16 v45, v88, v30
    v_dot2c_f32_bf16 v46, v89, v34
    v_dot2c_f32_bf16 v47, v89, v30
    v_dot2c_f32_bf16 v48, v90, v34
    v_dot2c_f32_bf16 v49, v90, v30
    v_dot2c_f32_bf16 v50, v91, v34
    v_dot2c_f32_bf16 v51, v91, v30
    s_cmp_eq_u32 s47, 0
    s_cselect_b32 s59, -2, -1
    s_and_b32 s61, s61, s59
    s_cmp_ge_u32 s47, 3
    s_cselect_b32 s59, 0, 0x100
    s_and_b32 s59, s61, s59
    s_bitcmp1_b32 s61, 0
    s_cselect_b64 vcc, -1, 0
    s_waitcnt vmcnt(3)
    buffer_load_dwordx4 v[80:83], v2, s[32:35], s36 offen offset:256 nt
    v_dot2c_f32_bf16 v52, v92, v34
    v_dot2c_f32_bf16 v53, v92, v30
    v_dot2c_f32_bf16 v54, v93, v34
    v_dot2c_f32_bf16 v55, v93, v30
    v_dot2c_f32_bf16 v56, v94, v34
    v_dot2c_f32_bf16 v57, v94, v30
    v_dot2c_f32_bf16 v58, v95, v34
    v_dot2c_f32_bf16 v59, v95, v30
    s_add_u32 s36, s36, 783360
    s_waitcnt vmcnt(3)
    buffer_load_dwordx4 v[84:87], v2, s[32:35], s36 offen offset:0 nt
    v_lshrrev_b32 v35, 16, v31
    v_mov_b32 v27, v31
    v_add_u32 v3, 128, v3
    ds_read_b128 v[28:31], v3 offset:2048
    v_dot2c_f32_bf16 v36, v96, v35
    v_dot2c_f32_bf16 v37, v96, v27
    v_dot2c_f32_bf16 v38, v97, v35
    v_dot2c_f32_bf16 v39, v97, v27
    v_dot2c_f32_bf16 v40, v98, v35
    v_dot2c_f32_bf16 v41, v98, v27
    v_dot2c_f32_bf16 v42, v99, v35
    v_dot2c_f32_bf16 v43, v99, v27
    s_waitcnt vmcnt(3)
    buffer_load_dwordx4 v[88:91], v2, s[32:35], s36 offen offset:128 nt
    v_dot2c_f32_bf16 v44, v100, v35
    v_dot2c_f32_bf16 v45, v100, v27
    v_dot2c_f32_bf16 v46, v101, v35
    v_dot2c_f32_bf16 v47, v101, v27
    v_dot2c_f32_bf16 v48, v102, v35
    v_dot2c_f32_bf16 v49, v102, v27
    v_dot2c_f32_bf16 v50, v103, v35
    v_dot2c_f32_bf16 v51, v103, v27
    s_waitcnt vmcnt(3)
    buffer_load_dwordx4 v[92:95], v2, s[32:35], s36 offen offset:256 nt
    v_dot2c_f32_bf16 v52, v104, v35
    v_dot2c_f32_bf16 v53, v104, v27
    v_dot2c_f32_bf16 v54, v105, v35
    v_dot2c_f32_bf16 v55, v105, v27
    v_dot2c_f32_bf16 v56, v106, v35
    v_dot2c_f32_bf16 v57, v106, v27
    v_dot2c_f32_bf16 v58, v107, v35
    v_dot2c_f32_bf16 v59, v107, v27
    s_add_u32 s36, s36, 3072
    s_nop 0
    s_branch L_ve
L_wpre:
    v_lshrrev_b32 v8, 4, v1
    v_and_b32 v9, 15, v1
    v_mul_u32_u24 v8, 3072, v8
    v_lshl_add_u32 v8, v9, 3, v8
    s_mul_i32 s46, s30, 12288
    s_add_u32 s46, s46, 33280
    v_add_u32 v8, s46, v8
    ds_read_b64 v[172:173], v8 offset:0
    ds_read_b64 v[174:175], v8 offset:128
    ds_read_b64 v[176:177], v8 offset:256
    ds_read_b64 v[178:179], v8 offset:384
    ds_read_b64 v[180:181], v8 offset:512
    ds_read_b64 v[182:183], v8 offset:640
    ds_read_b64 v[184:185], v8 offset:768
    ds_read_b64 v[186:187], v8 offset:896
    ds_read_b64 v[188:189], v8 offset:1024
    ds_read_b64 v[190:191], v8 offset:1152
    ds_read_b64 v[192:193], v8 offset:1280
    ds_read_b64 v[194:195], v8 offset:1408
    ds_read_b64 v[196:197], v8 offset:1536
    ds_read_b64 v[198:199], v8 offset:1664
    ds_read_b64 v[200:201], v8 offset:1792
    ds_read_b64 v[202:203], v8 offset:1920
    ds_read_b64 v[204:205], v8 offset:2048
    ds_read_b64 v[206:207], v8 offset:2176
    ds_read_b64 v[208:209], v8 offset:2304
    ds_read_b64 v[210:211], v8 offset:2432
    ds_read_b64 v[212:213], v8 offset:2560
    ds_read_b64 v[214:215], v8 offset:2688
    ds_read_b64 v[216:217], v8 offset:2816
    ds_read_b64 v[218:219], v8 offset:2944
    s_mul_i32 s46, s64, 98304
    s_mul_i32 s48, s67, 1536
    s_add_u32 s46, s46, s48
    s_mul_i32 s48, s30, 384
    s_add_u32 s46, s46, s48
    s_add_u32 s46, s46, 131072
    v_and_b32 v9, 31, v1
    v_mul_u32_u24 v6, 12, v9
    v_lshrrev_b32 v9, 5, v1
    v_mul_u32_u24 v9, 3072, v9
    v_add3_u32 v6, v6, v9, s46
    v_add_u32 v156, 0, v6
    v_add_u32 v157, 6144, v6
    v_add_u32 v158, 12288, v6
    v_add_u32 v159, 18432, v6
    v_add_u32 v160, 24576, v6
    v_add_u32 v161, 30720, v6
    v_add_u32 v162, 36864, v6
    v_add_u32 v163, 43008, v6
    v_add_u32 v164, 49152, v6
    v_add_u32 v165, 55296, v6
    v_add_u32 v166, 61440, v6
    v_add_u32 v167, 67584, v6
    v_add_u32 v168, 73728, v6
    v_add_u32 v169, 79872, v6
    v_add_u32 v170, 86016, v6
    v_add_u32 v171, 92160, v6
    s_waitcnt lgkmcnt(0)
    v_perm_b32 v108, v174, v172, s42
    v_perm_b32 v109, v174, v172, s43
    v_perm_b32 v110, v175, v173, s42
    v_perm_b32 v111, v175, v173, s43
    v_perm_b32 v112, v178, v176, s42
    v_perm_b32 v113, v178, v176, s43
    v_perm_b32 v114, v179, v177, s42
    v_perm_b32 v115, v179, v177, s43
    v_perm_b32 v116, v182, v180, s42
    v_perm_b32 v117, v182, v180, s43
    v_perm_b32 v118, v183, v181, s42
    v_perm_b32 v119, v183, v181, s43
    v_perm_b32 v120, v186, v184, s42
    v_perm_b32 v121, v186, v184, s43
    v_perm_b32 v122, v187, v185, s42
    v_perm_b32 v123, v187, v185, s43
    v_perm_b32 v124, v190, v188, s42
    v_perm_b32 v125, v190, v188, s43
    v_perm_b32 v126, v191, v189, s42
    v_perm_b32 v127, v191, v189, s43
    v_perm_b32 v128, v194, v192, s42
    v_perm_b32 v129, v194, v192, s43
    v_perm_b32 v130, v195, v193, s42
    v_perm_b32 v131, v195, v193, s43
    v_perm_b32 v132, v198, v196, s42
    v_perm_b32 v133, v198, v196, s43
    v_perm_b32 v134, v199, v197, s42
    v_perm_b32 v135, v199, v197, s43
    v_perm_b32 v136, v202, v200, s42
    v_perm_b32 v137, v202, v200, s43
    v_perm_b32 v138, v203, v201, s42
    v_perm_b32 v139, v203, v201, s43
    v_perm_b32 v140, v206, v204, s42
    v_perm_b32 v141, v206, v204, s43
    v_perm_b32 v142, v207, v205, s42
    v_perm_b32 v143, v207, v205, s43
    v_perm_b32 v144, v210, v208, s42
    v_perm_b32 v145, v210, v208, s43
    v_perm_b32 v146, v211, v209, s42
    v_perm_b32 v147, v211, v209, s43
    v_perm_b32 v148, v214, v212, s42
    v_perm_b32 v149, v214, v212, s43
    v_perm_b32 v150, v215, v213, s42
    v_perm_b32 v151, v215, v213, s43
    v_perm_b32 v152, v218, v216, s42
    v_perm_b32 v153, v218, v216, s43
    v_perm_b32 v154, v219, v217, s42
    v_perm_b32 v155, v219, v217, s43
    s_branch L_vphase
L_fpre:
    s_mul_i32 s45, s30, 160
    v_min_u32 v8, 39, v1
    v_lshl_add_u32 v8, v8, 2, s45
    v_and_b32 v9, 15, v8
    v_bfe_u32 v6, v8, 4, 2
    v_and_b32 v8, 0x3c0, v8
    v_lshl_add_u32 v8, v9, 2, v8
    v_add_lshl_u32 v8, v8, v6, 1
    v_mov_b32 v244, 0
    v_mov_b32 v245, 0
    v_mov_b32 v246, 0
    v_mov_b32 v247, 0
    global_load_short_d16_hi v244, v8, s[4:5] offset:0
    global_load_short_d16_hi v245, v8, s[4:5] offset:8
    global_load_short_d16_hi v246, v8, s[4:5] offset:16
    global_load_short_d16_hi v247, v8, s[4:5] offset:24
    s_lshl_b32 s46, s30, 4
    s_add_u32 s46, s46, 33280
    v_lshl_add_u32 v8, v1, 6, s46
    v_add_u32 v6, 40960, v8
    ds_read_b128 v[204:207], v8 offset:0
    ds_read_b128 v[208:211], v8 offset:4096
    ds_read_b128 v[212:215], v8 offset:8192
    ds_read_b128 v[216:219], v8 offset:12288
    ds_read_b128 v[220:223], v8 offset:16384
    ds_read_b128 v[224:227], v8 offset:20480
    ds_read_b128 v[228:231], v8 offset:24576
    ds_read_b128 v[232:235], v8 offset:28672
    ds_read_b128 v[236:239], v8 offset:32768
    ds_read_b128 v[240:243], v8 offset:36864
    s_waitcnt lgkmcnt(8)
    v_perm_b32 v108, v208, v204, s42
    v_perm_b32 v109, v208, v204, s43
    v_perm_b32 v110, v209, v205, s42
    v_perm_b32 v111, v209, v205, s43
    v_perm_b32 v112, v210, v206, s42
    v_perm_b32 v113, v210, v206, s43
    v_perm_b32 v114, v211, v207, s42
    v_perm_b32 v115, v211, v207, s43
    s_waitcnt lgkmcnt(6)
    v_perm_b32 v124, v216, v212, s42
    v_perm_b32 v125, v216, v212, s43
    v_perm_b32 v126, v217, v213, s42
    v_perm_b32 v127, v217, v213, s43
    v_perm_b32 v128, v218, v214, s42
    v_perm_b32 v129, v218, v214, s43
    v_perm_b32 v130, v219, v215, s42
    v_perm_b32 v131, v219, v215, s43
    s_waitcnt lgkmcnt(4)
    v_perm_b32 v140, v224, v220, s42
    v_perm_b32 v141, v224, v220, s43
    v_perm_b32 v142, v225, v221, s42
    v_perm_b32 v143, v225, v221, s43
    v_perm_b32 v144, v226, v222, s42
    v_perm_b32 v145, v226, v222, s43
    v_perm_b32 v146, v227, v223, s42
    v_perm_b32 v147, v227, v223, s43
    s_waitcnt lgkmcnt(2)
    v_perm_b32 v156, v232, v228, s42
    v_perm_b32 v157, v232, v228, s43
    v_perm_b32 v158, v233, v229, s42
    v_perm_b32 v159, v233, v229, s43
    v_perm_b32 v160, v234, v230, s42
    v_perm_b32 v161, v234, v230, s43
    v_perm_b32 v162, v235, v231, s42
    v_perm_b32 v163, v235, v231, s43
    s_waitcnt lgkmcnt(0)
    v_perm_b32 v172, v240, v236, s42
    v_perm_b32 v173, v240, v236, s43
    v_perm_b32 v174, v241, v237, s42
    v_perm_b32 v175, v241, v237, s43
    v_perm_b32 v176, v242, v238, s42
    v_perm_b32 v177, v242, v238, s43
    v_perm_b32 v178, v243, v239, s42
    v_perm_b32 v179, v243, v239, s43
    ds_read_b128 v[204:207], v6 offset:0
    ds_read_b128 v[208:211], v6 offset:4096
    ds_read_b128 v[212:215], v6 offset:8192
    ds_read_b128 v[216:219], v6 offset:12288
    ds_read_b128 v[220:223], v6 offset:16384
    ds_read_b128 v[224:227], v6 offset:20480
    s_waitcnt lgkmcnt(4)
    v_perm_b32 v116, v208, v204, s42
    v_perm_b32 v117, v208, v204, s43
    v_perm_b32 v118, v209, v205, s42
    v_perm_b32 v119, v209, v205, s43
    v_perm_b32 v120, v210, v206, s42
    v_perm_b32 v121, v210, v206, s43
    v_perm_b32 v122, v211, v207, s42
    v_perm_b32 v123, v211, v207, s43
    s_waitcnt lgkmcnt(2)
    v_perm_b32 v132, v216, v212, s42
    v_perm_b32 v133, v216, v212, s43
    v_perm_b32 v134, v217, v213, s42
    v_perm_b32 v135, v217, v213, s43
    v_perm_b32 v136, v218, v214, s42
    v_perm_b32 v137, v218, v214, s43
    v_perm_b32 v138, v219, v215, s42
    v_perm_b32 v139, v219, v215, s43
    s_waitcnt lgkmcnt(0)
    v_perm_b32 v148, v224, v220, s42
    v_perm_b32 v149, v224, v220, s43
    v_perm_b32 v150, v225, v221, s42
    v_perm_b32 v151, v225, v221, s43
    v_perm_b32 v152, v226, v222, s42
    v_perm_b32 v153, v226, v222, s43
    v_perm_b32 v154, v227, v223, s42
    v_perm_b32 v155, v227, v223, s43
    s_branch L_vphase
L_noq:
    s_waitcnt lgkmcnt(0)
    s_add_u32 s32, s6, s46
    s_addc_u32 s33, s7, 0
    s_add_u32 s38, s8, s46
    s_addc_u32 s39, s9, 0
    s_barrier
    s_cmp_lg_u32 s30, 4
    s_cbranch_scc1 L_stream
    s_load_dword s31, s[26:27], 0
    s_waitcnt lgkmcnt(0)
    s_add_u32 s31, s31, 1
    v_mov_b32 v29, s31
    s_branch L_hinit
L_helper:
    s_waitcnt lgkmcnt(0)
    s_add_u32 s31, s31, 1
    s_lshl_b32 s46, s77, 9
    s_add_u32 s46, s46, 1572864
    v_lshl_add_u32 v5, v1, 3, s46
    v_mov_b32 v29, s31
L_hqd:
    ds_read_b32 v27, v10 offset:24
    ds_read_b32 v12, v4 offset:18432
    ds_read_b32 v13, v4 offset:18688
    ds_read_b32 v14, v4 offset:18944
    ds_read_b32 v15, v4 offset:19200
    ds_read_b32 v16, v4 offset:19456
    s_waitcnt lgkmcnt(0)
    v_readfirstlane_b32 s46, v27
    s_nop 0
    s_cmp_eq_u32 s46, 5
    s_cbranch_scc1 L_hqd_ok
    s_sub_u32 s44, s44, 1
    s_cmp_eq_u32 s44, 0
    s_cbranch_scc1 L_exit
    s_branch L_hqd
L_hqd_ok:
    v_pk_add_f32 v[12:13], v[12:13], v[14:15]
    v_add_f32 v12, v12, v13
    v_add_f32 v28, v12, v16
    global_store_dwordx2 v5, v[28:29], s[26:27] sc1
L_hinit:
    v_mov_b32 v24, -1
    v_mov_b32 v25, -1
    v_mov_b32 v26, -1
    v_mov_b32 v27, -1
    s_lshl_b32 s45, s28, 5
    s_add_u32 s45, s45, s29
    s_mul_i32 s46, s45, 3072
    s_add_u32 s46, s46, 131072
    v_lshl_add_u32 v9, v1, 4, s46
    global_store_dwordx4 v9, v[24:27], s[26:27] offset:0 sc1
    global_store_dwordx4 v9, v[24:27], s[26:27] offset:1024 sc1
    global_store_dwordx4 v9, v[24:27], s[26:27] offset:2048 sc1
    s_lshl_b32 s45, s28, 7
    s_add_u32 s45, s45, s29
    s_lshl_b32 s46, s45, 3
    s_add_u32 s62, s46, 32768
    v_lshl_add_u32 v9, v1, 8, s62
    s_mov_b64 exec, 15
    global_store_dwordx2 v9, v[24:25], s[26:27] sc1
    s_mov_b64 exec, -1
    s_bitcmp0_b32 s69, 0
    s_cbranch_scc1 L_hnoap
    v_lshl_add_u32 v9, v1, 2, s53
    global_store_dword v9, v24, s[26:27] sc1
L_hnoap:
    s_bitcmp0_b32 s69, 1
    s_cbranch_scc1 L_hnofp
    s_mul_i32 s46, s71, 2560
    s_add_u32 s46, s46, 1048576
L_hfp:
    v_lshl_add_u32 v9, v1, 3, s46
    global_store_dwordx2 v9, v[24:25], s[26:27] offset:0 sc1
    global_store_dwordx2 v9, v[24:25], s[26:27] offset:512 sc1
    global_store_dwordx2 v9, v[24:25], s[26:27] offset:1024 sc1
    global_store_dwordx2 v9, v[24:25], s[26:27] offset:1536 sc1
    global_store_dwordx2 v9, v[24:25], s[26:27] offset:2048 sc1
    s_cmp_eq_u32 s46, 1048576
    s_mov_b32 s46, 1171456
    s_cbranch_scc1 L_hfp
L_hnofp:
    s_mul_i32 s46, s28, 3072
    s_add_u32 s46, s46, 1572864
    v_lshl_add_u32 v5, v1, 4, s46
    v_add_u32 v6, 24576, v5
    v_add_u32 v7, 49152, v5
    v_add_u32 v8, 73728, v5
    v_and_b32 v20, 31, v1
    v_lshlrev_b32 v20, 2, v20
    s_lshl_b32 s46, s2, 2
    s_add_u32 s46, s46, 4096
    v_mov_b32 v9, s46
    s_waitcnt vmcnt(0)
    s_mov_b64 exec, 1
    global_store_dword v9, v29, s[26:27] sc1
    s_mov_b64 exec, -1
L_hqw:
    ds_read_b32 v27, v10 offset:20
    s_waitcnt lgkmcnt(0)
    v_readfirstlane_b32 s46, v27
    s_nop 0
    s_cmp_lg_u32 s46, 0
    s_cbranch_scc1 L_hqw_ok
    s_sub_u32 s44, s44, 1
    s_cmp_eq_u32 s44, 0
    s_cbranch_scc1 L_exit
    s_sleep 2
    s_branch L_hqw
L_hqw_ok:
L_hq:
    global_load_dwordx4 v[40:43], v5, s[26:27] offset:0 sc1
    global_load_dwordx4 v[44:47], v5, s[26:27] offset:1024 sc1
    global_load_dwordx4 v[48:51], v5, s[26:27] offset:2048 sc1
    global_load_dwordx4 v[52:55], v6, s[26:27] offset:0 sc1
    global_load_dwordx4 v[56:59], v6, s[26:27] offset:1024 sc1
    global_load_dwordx4 v[60:63], v6, s[26:27] offset:2048 sc1
    global_load_dwordx4 v[64:67], v7, s[26:27] offset:0 sc1
    global_load_dwordx4 v[68:71], v7, s[26:27] offset:1024 sc1
    global_load_dwordx4 v[72:75], v7, s[26:27] offset:2048 sc1
    global_load_dwordx4 v[76:79], v8, s[26:27] offset:0 sc1
    global_load_dwordx4 v[80:83], v8, s[26:27] offset:1024 sc1
    global_load_dwordx4 v[84:87], v8, s[26:27] offset:2048 sc1
    s_waitcnt vmcnt(0)
    v_min_u32 v24, v41, v43
    v_max_u32 v25, v41, v43
    v_min3_u32 v24, v24, v45, v47
    v_max3_u32 v25, v25, v45, v47
    v_min3_u32 v24, v24, v49, v51
    v_max3_u32 v25, v25, v49, v51
    v_min3_u32 v24, v24, v53, v55
    v_max3_u32 v25, v25, v53, v55
    v_min3_u32 v24, v24, v57, v59
    v_max3_u32 v25, v25, v57, v59
    v_min3_u32 v24, v24, v61, v63
    v_max3_u32 v25, v25, v61, v63
    v_min3_u32 v24, v24, v65, v67
    v_max3_u32 v25, v25, v65, v67
    v_min3_u32 v24, v24, v69, v71
    v_max3_u32 v25, v25, v69, v71
    v_min3_u32 v24, v24, v73, v75
    v_max3_u32 v25, v25, v73, v75
    v_min3_u32 v24, v24, v77, v79
    v_max3_u32 v25, v25, v77, v79
    v_min3_u32 v24, v24, v81, v83
    v_max3_u32 v25, v25, v81, v83
    v_min3_u32 v24, v24, v85, v87
    v_max3_u32 v25, v25, v85, v87
    v_cmp_ne_u32 vcc, s31, v24
    v_cmp_ne_u32 s[46:47], s31, v25
    s_nop 0
    s_or_b64 vcc, vcc, s[46:47]
    s_cbranch_scc0 L_hqok
    s_sub_u32 s44, s44, 1
    s_cmp_eq_u32 s44, 0
    s_cbranch_scc1 L_exit
    s_sleep 8
    s_branch L_hq
L_hqok:
    v_mov_b32 v41, v40
    v_mov_b32 v43, v42
    v_mov_b32 v45, v44
    v_mov_b32 v47, v46
    v_mov_b32 v49, v48
    v_mov_b32 v51, v50
    v_mov_b32 v53, v52
    v_mov_b32 v55, v54
    v_mov_b32 v57, v56
    v_mov_b32 v59, v58
    v_mov_b32 v61, v60
    v_mov_b32 v63, v62
    v_mov_b32 v65, v64
    v_mov_b32 v67, v66
    v_mov_b32 v69, v68
    v_mov_b32 v71, v70
    v_mov_b32 v73, v72
    v_mov_b32 v75, v74
    v_mov_b32 v77, v76
    v_mov_b32 v79, v78
    v_mov_b32 v81, v80
    v_mov_b32 v83, v82
    v_mov_b32 v85, v84
    v_mov_b32 v87, v86
    v_permlane32_swap_b32 v40, v41
    v_permlane32_swap_b32 v42, v43
    v_permlane32_swap_b32 v44, v45
    v_permlane32_swap_b32 v46, v47
    v_permlane32_swap_b32 v48, v49
    v_permlane32_swap_b32 v50, v51
    v_permlane32_swap_b32 v52, v53
    v_permlane32_swap_b32 v54, v55
    v_permlane32_swap_b32 v56, v57
    v_permlane32_swap_b32 v58, v59
    v_permlane32_swap_b32 v60, v61
    v_permlane32_swap_b32 v62, v63
    v_permlane32_swap_b32 v64, v65
    v_permlane32_swap_b32 v66, v67
    v_permlane32_swap_b32 v68, v69
    v_permlane32_swap_b32 v70, v71
    v_permlane32_swap_b32 v72, v73
    v_permlane32_swap_b32 v74, v75
    v_permlane32_swap_b32 v76, v77
    v_permlane32_swap_b32 v78, v79
    v_permlane32_swap_b32 v80, v81
    v_permlane32_swap_b32 v82, v83
    v_permlane32_swap_b32 v84, v85
    v_permlane32_swap_b32 v86, v87
    v_add_f32 v40, v40, v41
    v_add_f32 v42, v42, v43
    v_add_f32 v44, v44, v45
    v_add_f32 v46, v46, v47
    v_add_f32 v48, v48, v49
    v_add_f32 v50, v50, v51
    v_add_f32 v52, v52, v53
    v_add_f32 v54, v54, v55
    v_add_f32 v56, v56, v57
    v_add_f32 v58, v58, v59
    v_add_f32 v60, v60, v61
    v_add_f32 v62, v62, v63
    v_add_f32 v64, v64, v65
    v_add_f32 v66, v66, v67
    v_add_f32 v68, v68, v69
    v_add_f32 v70, v70, v71
    v_add_f32 v72, v72, v73
    v_add_f32 v74, v74, v75
    v_add_f32 v76, v76, v77
    v_add_f32 v78, v78, v79
    v_add_f32 v80, v80, v81
    v_add_f32 v82, v82, v83
    v_add_f32 v84, v84, v85
    v_add_f32 v86, v86, v87
    v_cvt_pk_bf16_f32 v40, v40, v42
    ds_write_b32 v20, v40 offset:512
    v_cvt_pk_bf16_f32 v44, v44, v46
    ds_write_b32 v20, v44 offset:640
    v_cvt_pk_bf16_f32 v48, v48, v50
    ds_write_b32 v20, v48 offset:768
    v_cvt_pk_bf16_f32 v52, v52, v54
    ds_write_b32 v20, v52 offset:896
    v_cvt_pk_bf16_f32 v56, v56, v58
    ds_write_b32 v20, v56 offset:1024
    v_cvt_pk_bf16_f32 v60, v60, v62
    ds_write_b32 v20, v60 offset:1152
    v_cvt_pk_bf16_f32 v64, v64, v66
    ds_write_b32 v20, v64 offset:1280
    v_cvt_pk_bf16_f32 v68, v68, v70
    ds_write_b32 v20, v68 offset:1408
    v_cvt_pk_bf16_f32 v72, v72, v74
    ds_write_b32 v20, v72 offset:1536
    v_cvt_pk_bf16_f32 v76, v76, v78
    ds_write_b32 v20, v76 offset:1664
    v_cvt_pk_bf16_f32 v80, v80, v82
    ds_write_b32 v20, v80 offset:1792
    v_cvt_pk_bf16_f32 v84, v84, v86
    ds_write_b32 v20, v84 offset:1920
    s_waitcnt lgkmcnt(0)
    s_barrier
    s_mov_b32 s52, 8
    v_lshlrev_b32 v6, 4, v1
    v_mov_b32 v7, s62
    s_lshl_b32 s46, s28, 10
    s_add_u32 s46, s46, 32768
    v_and_b32 v8, 31, v1
    v_lshl_add_u32 v8, v8, 3, s46
    s_mov_b32 s54, 0x3d93cd3a
    s_mov_b32 s55, 0x3fb8aa3b
    v_add_u32 v9, 4096, v6
L_hk:
    ds_read_b128 v[16:19], v10 offset:0
    s_waitcnt lgkmcnt(0)
    v_min_u32 v16, v16, v17
    v_min3_u32 v16, v16, v18, v19
    s_nop 0
    v_readfirstlane_b32 s46, v16
    s_nop 0
    s_cmp_ge_u32 s46, s52
    s_cbranch_scc1 L_hk0
    s_sub_u32 s44, s44, 1
    s_cmp_eq_u32 s44, 0
    s_cbranch_scc1 L_exit
    s_sleep 16
    s_branch L_hk
L_hk0:
    s_cmp_eq_u32 s52, 8
    s_cbranch_scc1 L_hk1
L_hst:
    global_load_dwordx2 v[22:23], v8, s[26:27] sc1
    s_waitcnt vmcnt(0)
    v_max_u32 v24, v22, v23
    v_cmp_eq_u32 vcc, -1, v24
    s_cbranch_vccz L_hstok
    s_sub_u32 s44, s44, 1
    s_cmp_eq_u32 s44, 0
    s_cbranch_scc1 L_exit
    s_sleep 32
    s_branch L_hst
L_hstok:
    v_mov_b32 v24, v22
    s_nop 1
    v_max_f32_dpp v24, v24, v24 quad_perm:[1,0,3,2] row_mask:0xf bank_mask:0xf
    s_nop 1
    v_max_f32_dpp v24, v24, v24 quad_perm:[2,3,0,1] row_mask:0xf bank_mask:0xf
    s_nop 1
    v_max_f32_dpp v24, v24, v24 row_half_mirror row_mask:0xf bank_mask:0xf
    s_nop 1
    v_max_f32_dpp v24, v24, v24 row_mirror row_mask:0xf bank_mask:0xf
    s_nop 1
    v_max_f32_dpp v24, v24, v24 row_bcast:15 row_mask:0xa bank_mask:0xf
    s_nop 1
    v_max_f32_dpp v24, v24, v24 row_bcast:31 row_mask:0xc bank_mask:0xf
    s_nop 0
    v_readlane_b32 s56, v24, 63
    s_nop 1
    v_subrev_f32 v22, s56, v22
    v_mul_f32 v22, s55, v22
    v_exp_f32 v22, v22
    s_nop 0
    v_mul_f32 v22, v22, v23
    s_nop 1
    v_add_f32_dpp v22, v22, v22 quad_perm:[1,0,3,2] row_mask:0xf bank_mask:0xf
    s_nop 1
    v_add_f32_dpp v22, v22, v22 quad_perm:[2,3,0,1] row_mask:0xf bank_mask:0xf
    s_nop 1
    v_add_f32_dpp v22, v22, v22 row_half_mirror row_mask:0xf bank_mask:0xf
    s_nop 1
    v_add_f32_dpp v22, v22, v22 row_mirror row_mask:0xf bank_mask:0xf
    s_nop 1
    v_add_f32_dpp v22, v22, v22 row_bcast:15 row_mask:0xa bank_mask:0xf
    s_nop 1
    v_add_f32_dpp v22, v22, v22 row_bcast:31 row_mask:0xc bank_mask:0xf
    s_nop 0
    v_readlane_b32 s57, v22, 63
    s_nop 1
    v_mul_f32_e64 v22, s57, 0.5
    v_rcp_f32 v23, v22
    s_nop 0
    v_fma_f32 v24, -v22, v23, 1.0
    v_fma_f32 v23, v24, v23, v23
    v_subrev_f32 v32, s56, v32
    v_mul_f32 v32, s55, v32
    v_exp_f32 v32, v32
    s_nop 0
    v_mul_f32 v32, v32, v23
    v_cvt_pk_bf16_f32 v32, 0, v32
    v_subrev_f32 v33, s56, v33
    v_mul_f32 v33, s55, v33
    v_exp_f32 v33, v33
    s_nop 0
    v_mul_f32 v33, v33, v23
    v_cvt_pk_bf16_f32 v33, 0, v33
    v_subrev_f32 v34, s56, v34
    v_mul_f32 v34, s55, v34
    v_exp_f32 v34, v34
    s_nop 0
    v_mul_f32 v34, v34, v23
    v_cvt_pk_bf16_f32 v34, 0, v34
    v_subrev_f32 v35, s56, v35
    v_mul_f32 v35, s55, v35
    v_exp_f32 v35, v35
    s_nop 0
    v_mul_f32 v35, v35, v23
    v_cvt_pk_bf16_f32 v35, 0, v35
    v_subrev_f32 v36, s56, v36
    v_mul_f32 v36, s55, v36
    v_exp_f32 v36, v36
    s_nop 0
    v_mul_f32 v36, v36, v23
    v_cvt_pk_bf16_f32 v36, 0, v36
    v_subrev_f32 v37, s56, v37
    v_mul_f32 v37, s55, v37
    v_exp_f32 v37, v37
    s_nop 0
    v_mul_f32 v37, v37, v23
    v_cvt_pk_bf16_f32 v37, 0, v37
    v_subrev_f32 v38, s56, v38
    v_mul_f32 v38, s55, v38
    v_exp_f32 v38, v38
    s_nop 0
    v_mul_f32 v38, v38, v23
    v_cvt_pk_bf16_f32 v38, 0, v38
    v_subrev_f32 v39, s56, v39
    v_mul_f32 v39, s55, v39
    v_exp_f32 v39, v39
    s_nop 0
    v_mul_f32 v39, v39, v23
    v_cvt_pk_bf16_f32 v39, 0, v39
    v_subrev_f32 v40, s56, v40
    v_mul_f32 v40, s55, v40
    v_exp_f32 v40, v40
    s_nop 0
    v_mul_f32 v40, v40, v23
    v_cvt_pk_bf16_f32 v40, 0, v40
    v_subrev_f32 v41, s56, v41
    v_mul_f32 v41, s55, v41
    v_exp_f32 v41, v41
    s_nop 0
    v_mul_f32 v41, v41, v23
    v_cvt_pk_bf16_f32 v41, 0, v41
    v_subrev_f32 v42, s56, v42
    v_mul_f32 v42, s55, v42
    v_exp_f32 v42, v42
    s_nop 0
    v_mul_f32 v42, v42, v23
    v_cvt_pk_bf16_f32 v42, 0, v42
    v_subrev_f32 v43, s56, v43
    v_mul_f32 v43, s55, v43
    v_exp_f32 v43, v43
    s_nop 0
    v_mul_f32 v43, v43, v23
    v_cvt_pk_bf16_f32 v43, 0, v43
    v_subrev_f32 v44, s56, v44
    v_mul_f32 v44, s55, v44
    v_exp_f32 v44, v44
    s_nop 0
    v_mul_f32 v44, v44, v23
    v_cvt_pk_bf16_f32 v44, 0, v44
    v_subrev_f32 v45, s56, v45
    v_mul_f32 v45, s55, v45
    v_exp_f32 v45, v45
    s_nop 0
    v_mul_f32 v45, v45, v23
    v_cvt_pk_bf16_f32 v45, 0, v45
    v_subrev_f32 v46, s56, v46
    v_mul_f32 v46, s55, v46
    v_exp_f32 v46, v46
    s_nop 0
    v_mul_f32 v46, v46, v23
    v_cvt_pk_bf16_f32 v46, 0, v46
    v_subrev_f32 v47, s56, v47
    v_mul_f32 v47, s55, v47
    v_exp_f32 v47, v47
    s_nop 0
    v_mul_f32 v47, v47, v23
    v_cvt_pk_bf16_f32 v47, 0, v47
    ds_write_b128 v6, v[32:35] offset:2048
    ds_write_b128 v6, v[36:39] offset:6144
    ds_write_b128 v6, v[40:43] offset:10240
    ds_write_b128 v6, v[44:47] offset:14336
    s_lshr_b32 s46, s52, 3
    s_sub_u32 s46, s46, 1
    v_mov_b32 v20, s46
    ds_write_b32 v10, v20 offset:16
    v_add_u32 v6, 1024, v6
    v_add_u32 v8, 256, v8
    s_cmp_lg_u32 s52, 40
    s_cbranch_scc1 L_hk2
    s_lshl_b32 s45, s28, 5
    s_add_u32 s45, s45, s29
    s_mul_i32 s45, s45, 3072
    s_add_u32 s45, s45, 131072
    v_mul_u32_u24 v6, 12, v1
    v_add_u32 v6, s45, v6
L_hp:
    ds_read_b128 v[16:19], v10 offset:0
    s_waitcnt lgkmcnt(0)
    v_min_u32 v16, v16, v17
    v_min3_u32 v16, v16, v18, v19
    s_nop 0
    v_readfirstlane_b32 s46, v16
    s_nop 0
    s_cmp_ge_u32 s46, 62
    s_cbranch_scc1 L_hp_ok
    s_sub_u32 s44, s44, 1
    s_cmp_eq_u32 s44, 0
    s_cbranch_scc1 L_exit
    s_sleep 4
    s_branch L_hp
L_hp_ok:
    ds_read_b32 v32, v4 offset:18432
    ds_read_b32 v36, v4 offset:18688
    ds_read_b32 v40, v4 offset:18944
    ds_read_b32 v33, v4 offset:19200
    ds_read_b32 v37, v4 offset:19456
    ds_read_b32 v41, v4 offset:19712
    ds_read_b32 v34, v4 offset:19968
    ds_read_b32 v38, v4 offset:20224
    ds_read_b32 v42, v4 offset:20480
    ds_read_b32 v35, v4 offset:20736
    ds_read_b32 v39, v4 offset:20992
    ds_read_b32 v43, v4 offset:21248
    ds_read_b32 v44, v4 offset:21504
    ds_read_b32 v48, v4 offset:21760
    ds_read_b32 v52, v4 offset:22016
    ds_read_b32 v45, v4 offset:22272
    ds_read_b32 v49, v4 offset:22528
    ds_read_b32 v53, v4 offset:22784
    ds_read_b32 v46, v4 offset:23040
    ds_read_b32 v50, v4 offset:23296
    ds_read_b32 v54, v4 offset:23552
    ds_read_b32 v47, v4 offset:23808
    ds_read_b32 v51, v4 offset:24064
    ds_read_b32 v55, v4 offset:24320
    ds_read_b32 v56, v4 offset:24576
    ds_read_b32 v60, v4 offset:24832
    ds_read_b32 v64, v4 offset:25088
    ds_read_b32 v57, v4 offset:25344
    ds_read_b32 v61, v4 offset:25600
    ds_read_b32 v65, v4 offset:25856
    ds_read_b32 v58, v4 offset:26112
    ds_read_b32 v62, v4 offset:26368
    ds_read_b32 v66, v4 offset:26624
    ds_read_b32 v59, v4 offset:26880
    ds_read_b32 v63, v4 offset:27136
    ds_read_b32 v67, v4 offset:27392
    s_waitcnt lgkmcnt(0)
    v_pk_add_f32 v[32:33], v[32:33], v[34:35]
    v_pk_add_f32 v[36:37], v[36:37], v[38:39]
    v_pk_add_f32 v[40:41], v[40:41], v[42:43]
    v_add_f32 v12, v32, v33
    v_add_f32 v13, v36, v37
    v_add_f32 v14, v40, v41
    v_min_u32 v12, -2, v12
    v_min_u32 v13, -2, v13
    v_min_u32 v14, -2, v14
    global_store_dwordx3 v6, v[12:14], s[26:27] offset:0 sc1
    v_pk_add_f32 v[44:45], v[44:45], v[46:47]
    v_pk_add_f32 v[48:49], v[48:49], v[50:51]
    v_pk_add_f32 v[52:53], v[52:53], v[54:55]
    v_add_f32 v16, v44, v45
    v_add_f32 v17, v48, v49
    v_add_f32 v18, v52, v53
    v_min_u32 v16, -2, v16
    v_min_u32 v17, -2, v17
    v_min_u32 v18, -2, v18
    global_store_dwordx3 v6, v[16:18], s[26:27] offset:768 sc1
    v_pk_add_f32 v[56:57], v[56:57], v[58:59]
    v_pk_add_f32 v[60:61], v[60:61], v[62:63]
    v_pk_add_f32 v[64:65], v[64:65], v[66:67]
    v_add_f32 v20, v56, v57
    v_add_f32 v21, v60, v61
    v_add_f32 v22, v64, v65
    v_min_u32 v20, -2, v20
    v_min_u32 v21, -2, v21
    v_min_u32 v22, -2, v22
    global_store_dwordx3 v6, v[20:22], s[26:27] offset:1536 sc1
    s_branch L_fin
L_hk1:
    global_load_dwordx4 v[20:23], v9, s[26:27] sc1
    s_waitcnt vmcnt(0)
    v_min_u32 v24, v20, v21
    v_max_u32 v25, v20, v21
    v_min3_u32 v24, v24, v22, v23
    v_max3_u32 v25, v25, v22, v23
    v_cmp_ne_u32 vcc, s31, v24
    v_cmp_ne_u32 s[46:47], s31, v25
    s_nop 0
    s_or_b64 vcc, vcc, s[46:47]
    s_cbranch_scc0 L_hk2
    s_sub_u32 s44, s44, 1
    s_cmp_eq_u32 s44, 0
    s_cbranch_scc1 L_exit
    s_sleep 32
    s_branch L_hk1
L_hk2:
    ds_read_b128 v[32:35], v6 offset:2048
    ds_read_b128 v[36:39], v6 offset:6144
    ds_read_b128 v[40:43], v6 offset:10240
    ds_read_b128 v[44:47], v6 offset:14336
    s_waitcnt lgkmcnt(0)
    v_cvt_pk_bf16_f32 v32, 0, v32
    v_mul_f32 v32, s54, v32
    v_cvt_pk_bf16_f32 v32, 0, v32
    v_cvt_pk_bf16_f32 v33, 0, v33
    v_mul_f32 v33, s54, v33
    v_cvt_pk_bf16_f32 v33, 0, v33
    v_cvt_pk_bf16_f32 v34, 0, v34
    v_mul_f32 v34, s54, v34
    v_cvt_pk_bf16_f32 v34, 0, v34
    v_cvt_pk_bf16_f32 v35, 0, v35
    v_mul_f32 v35, s54, v35
    v_cvt_pk_bf16_f32 v35, 0, v35
    v_cvt_pk_bf16_f32 v36, 0, v36
    v_mul_f32 v36, s54, v36
    v_cvt_pk_bf16_f32 v36, 0, v36
    v_cvt_pk_bf16_f32 v37, 0, v37
    v_mul_f32 v37, s54, v37
    v_cvt_pk_bf16_f32 v37, 0, v37
    v_cvt_pk_bf16_f32 v38, 0, v38
    v_mul_f32 v38, s54, v38
    v_cvt_pk_bf16_f32 v38, 0, v38
    v_cvt_pk_bf16_f32 v39, 0, v39
    v_mul_f32 v39, s54, v39
    v_cvt_pk_bf16_f32 v39, 0, v39
    v_cvt_pk_bf16_f32 v40, 0, v40
    v_mul_f32 v40, s54, v40
    v_cvt_pk_bf16_f32 v40, 0, v40
    v_cvt_pk_bf16_f32 v41, 0, v41
    v_mul_f32 v41, s54, v41
    v_cvt_pk_bf16_f32 v41, 0, v41
    v_cvt_pk_bf16_f32 v42, 0, v42
    v_mul_f32 v42, s54, v42
    v_cvt_pk_bf16_f32 v42, 0, v42
    v_cvt_pk_bf16_f32 v43, 0, v43
    v_mul_f32 v43, s54, v43
    v_cvt_pk_bf16_f32 v43, 0, v43
    v_cvt_pk_bf16_f32 v44, 0, v44
    v_mul_f32 v44, s54, v44
    v_cvt_pk_bf16_f32 v44, 0, v44
    v_cvt_pk_bf16_f32 v45, 0, v45
    v_mul_f32 v45, s54, v45
    v_cvt_pk_bf16_f32 v45, 0, v45
    v_cvt_pk_bf16_f32 v46, 0, v46
    v_mul_f32 v46, s54, v46
    v_cvt_pk_bf16_f32 v46, 0, v46
    v_cvt_pk_bf16_f32 v47, 0, v47
    v_mul_f32 v47, s54, v47
    v_cvt_pk_bf16_f32 v47, 0, v47
    v_max3_f32 v20, v32, v33, v34
    v_max3_f32 v20, v20, v35, v36
    v_max3_f32 v20, v20, v37, v38
    v_max3_f32 v20, v20, v39, v40
    v_max3_f32 v20, v20, v41, v42
    v_max3_f32 v20, v20, v43, v44
    v_max3_f32 v20, v20, v45, v46
    v_max_f32 v20, v20, v47
    v_max_f32 v20, 0xff7fffff, v20
    s_nop 1
    v_max_f32_dpp v20, v20, v20 quad_perm:[1,0,3,2] row_mask:0xf bank_mask:0xf
    s_nop 1
    v_max_f32_dpp v20, v20, v20 quad_perm:[2,3,0,1] row_mask:0xf bank_mask:0xf
    s_nop 1
    v_max_f32_dpp v20, v20, v20 row_half_mirror row_mask:0xf bank_mask:0xf
    s_nop 1
    v_max_f32_dpp v20, v20, v20 row_mirror row_mask:0xf bank_mask:0xf
    s_nop 1
    v_max_f32_dpp v20, v20, v20 row_bcast:15 row_mask:0xa bank_mask:0xf
    s_nop 1
    v_max_f32_dpp v20, v20, v20 row_bcast:31 row_mask:0xc bank_mask:0xf
    s_nop 0
    v_readlane_b32 s56, v20, 63
    v_mov_b32 v21, 0
    s_nop 0
    v_subrev_f32 v22, s56, v32
    v_mul_f32 v22, s55, v22
    v_exp_f32 v22, v22
    s_nop 0
    v_add_f32 v21, v21, v22
    v_subrev_f32 v22, s56, v33
    v_mul_f32 v22, s55, v22
    v_exp_f32 v22, v22
    s_nop 0
    v_add_f32 v21, v21, v22
    v_subrev_f32 v22, s56, v34
    v_mul_f32 v22, s55, v22
    v_exp_f32 v22, v22
    s_nop 0
    v_add_f32 v21, v21, v22
    v_subrev_f32 v22, s56, v35
    v_mul_f32 v22, s55, v22
    v_exp_f32 v22, v22
    s_nop 0
    v_add_f32 v21, v21, v22
    v_subrev_f32 v22, s56, v36
    v_mul_f32 v22, s55, v22
    v_exp_f32 v22, v22
    s_nop 0
    v_add_f32 v21, v21, v22
    v_subrev_f32 v22, s56, v37
    v_mul_f32 v22, s55, v22
    v_exp_f32 v22, v22
    s_nop 0
    v_add_f32 v21, v21, v22
    v_subrev_f32 v22, s56, v38
    v_mul_f32 v22, s55, v22
    v_exp_f32 v22, v22
    s_nop 0
    v_add_f32 v21, v21, v22
    v_subrev_f32 v22, s56, v39
    v_mul_f32 v22, s55, v22
    v_exp_f32 v22, v22
    s_nop 0
    v_add_f32 v21, v21, v22
    v_subrev_f32 v22, s56, v40
    v_mul_f32 v22, s55, v22
    v_exp_f32 v22, v22
    s_nop 0
    v_add_f32 v21, v21, v22
    v_subrev_f32 v22, s56, v41
    v_mul_f32 v22, s55, v22
    v_exp_f32 v22, v22
    s_nop 0
    v_add_f32 v21, v21, v22
    v_subrev_f32 v22, s56, v42
    v_mul_f32 v22, s55, v22
    v_exp_f32 v22, v22
    s_nop 0
    v_add_f32 v21, v21, v22
    v_subrev_f32 v22, s56, v43
    v_mul_f32 v22, s55, v22
    v_exp_f32 v22, v22
    s_nop 0
    v_add_f32 v21, v21, v22
    v_subrev_f32 v22, s56, v44
    v_mul_f32 v22, s55, v22
    v_exp_f32 v22, v22
    s_nop 0
    v_add_f32 v21, v21, v22
    v_subrev_f32 v22, s56, v45
    v_mul_f32 v22, s55, v22
    v_exp_f32 v22, v22
    s_nop 0
    v_add_f32 v21, v21, v22
    v_subrev_f32 v22, s56, v46
    v_mul_f32 v22, s55, v22
    v_exp_f32 v22, v22
    s_nop 0
    v_add_f32 v21, v21, v22
    v_subrev_f32 v22, s56, v47
    v_mul_f32 v22, s55, v22
    v_exp_f32 v22, v22
    s_nop 0
    v_add_f32 v21, v21, v22
    s_nop 1
    v_add_f32_dpp v21, v21, v21 quad_perm:[1,0,3,2] row_mask:0xf bank_mask:0xf
    s_nop 1
    v_add_f32_dpp v21, v21, v21 quad_perm:[2,3,0,1] row_mask:0xf bank_mask:0xf
    s_nop 1
    v_add_f32_dpp v21, v21, v21 row_half_mirror row_mask:0xf bank_mask:0xf
    s_nop 1
    v_add_f32_dpp v21, v21, v21 row_mirror row_mask:0xf bank_mask:0xf
    s_nop 1
    v_add_f32_dpp v21, v21, v21 row_bcast:15 row_mask:0xa bank_mask:0xf
    s_nop 1
    v_add_f32_dpp v21, v21, v21 row_bcast:31 row_mask:0xc bank_mask:0xf
    s_nop 0
    v_readlane_b32 s57, v21, 63
    v_mov_b32 v20, s56
    s_nop 0
    v_mov_b32 v21, s57
    v_min_u32 v20, -2, v20
    v_min_u32 v21, -2, v21
    s_mov_b64 exec, 1
    global_store_dwordx2 v7, v[20:21], s[26:27] sc1
    s_mov_b64 exec, -1
    v_add_u32 v7, 256, v7
    s_add_u32 s52, s52, 8
    s_branch L_hk
L_aux:
    s_mov_b32 exec_lo, 0xffff
    s_mov_b32 exec_hi, 0
    ds_write_b32 v4, v10
    s_mov_b64 exec, -1
    s_mov_b32 s75, 0x20000
    s_mov_b32 s70, 33280
    s_mov_b32 s52, 0
    s_waitcnt lgkmcnt(0)
    s_barrier
    s_load_dword s31, s[26:27], 0
    s_bitcmp0_b32 s69, 0
    s_cbranch_scc1 L_a1
    s_mov_b32 s72, s12
    s_mov_b32 s73, s13
    s_mov_b32 s74, 7864320
    v_mul_u32_u24 v12, 10240, v7
    v_lshl_add_u32 v12, v8, 4, v12
    s_lshl_b32 s47, s67, 4
    s_add_u32 s47, s47, s64
    s_mul_i32 s47, s47, 245760
    s_lshl_b32 s48, s65, 7
    s_add_u32 s47, s47, s48
L_awo:
    s_mov_b32 m0, s70
    s_add_u32 s70, s70, 1024
    buffer_load_dwordx4 v12, s[72:75], s47 offen nt lds
    s_add_u32 s47, s47, 1280
    s_mov_b32 m0, s70
    s_add_u32 s70, s70, 1024
    buffer_load_dwordx4 v12, s[72:75], s47 offen nt lds
    s_add_u32 s47, s47, 1280
    s_mov_b32 m0, s70
    s_add_u32 s70, s70, 1024
    buffer_load_dwordx4 v12, s[72:75], s47 offen nt lds
    s_add_u32 s47, s47, 1280
    s_mov_b32 m0, s70
    s_add_u32 s70, s70, 1024
    buffer_load_dwordx4 v12, s[72:75], s47 offen nt lds
    s_add_u32 s47, s47, 1280
    s_mov_b32 m0, s70
    s_add_u32 s70, s70, 1024
    buffer_load_dwordx4 v12, s[72:75], s47 offen nt lds
    s_add_u32 s47, s47, 1280
    s_mov_b32 m0, s70
    s_add_u32 s70, s70, 1024
    buffer_load_dwordx4 v12, s[72:75], s47 offen nt lds
    s_add_u32 s47, s47, 1280
    s_mov_b32 m0, s70
    s_add_u32 s70, s70, 1024
    buffer_load_dwordx4 v12, s[72:75], s47 offen nt lds
    s_add_u32 s47, s47, 1280
    s_mov_b32 m0, s70
    s_add_u32 s70, s70, 1024
    buffer_load_dwordx4 v12, s[72:75], s47 offen nt lds
    s_add_u32 s47, s47, 72960
    s_mov_b32 m0, s70
    s_add_u32 s70, s70, 1024
    buffer_load_dwordx4 v12, s[72:75], s47 offen nt lds
    s_add_u32 s47, s47, 1280
    s_mov_b32 m0, s70
    s_add_u32 s70, s70, 1024
    buffer_load_dwordx4 v12, s[72:75], s47 offen nt lds
    s_add_u32 s47, s47, 1280
    s_mov_b32 m0, s70
    s_add_u32 s70, s70, 1024
    buffer_load_dwordx4 v12, s[72:75], s47 offen nt lds
    s_add_u32 s47, s47, 1280
    s_mov_b32 m0, s70
    s_add_u32 s70, s70, 1024
    buffer_load_dwordx4 v12, s[72:75], s47 offen nt lds
    s_add_u32 s47, s47, 1280
    s_mov_b32 m0, s70
    s_add_u32 s70, s70, 1024
    buffer_load_dwordx4 v12, s[72:75], s47 offen nt lds
    s_add_u32 s47, s47, 1280
    s_mov_b32 m0, s70
    s_add_u32 s70, s70, 1024
    buffer_load_dwordx4 v12, s[72:75], s47 offen nt lds
    s_add_u32 s47, s47, 1280
    s_mov_b32 m0, s70
    s_add_u32 s70, s70, 1024
    buffer_load_dwordx4 v12, s[72:75], s47 offen nt lds
    s_add_u32 s47, s47, 1280
    s_mov_b32 m0, s70
    s_add_u32 s70, s70, 1024
    buffer_load_dwordx4 v12, s[72:75], s47 offen nt lds
    s_add_u32 s47, s47, 72960
    s_mov_b32 m0, s70
    s_add_u32 s70, s70, 1024
    buffer_load_dwordx4 v12, s[72:75], s47 offen nt lds
    s_add_u32 s47, s47, 1280
    s_mov_b32 m0, s70
    s_add_u32 s70, s70, 1024
    buffer_load_dwordx4 v12, s[72:75], s47 offen nt lds
    s_add_u32 s47, s47, 1280
    s_mov_b32 m0, s70
    s_add_u32 s70, s70, 1024
    buffer_load_dwordx4 v12, s[72:75], s47 offen nt lds
    s_add_u32 s47, s47, 1280
    s_mov_b32 m0, s70
    s_add_u32 s70, s70, 1024
    buffer_load_dwordx4 v12, s[72:75], s47 offen nt lds
    s_add_u32 s47, s47, 1280
    s_mov_b32 m0, s70
    s_add_u32 s70, s70, 1024
    buffer_load_dwordx4 v12, s[72:75], s47 offen nt lds
    s_add_u32 s47, s47, 1280
    s_mov_b32 m0, s70
    s_add_u32 s70, s70, 1024
    buffer_load_dwordx4 v12, s[72:75], s47 offen nt lds
    s_add_u32 s47, s47, 1280
    s_mov_b32 m0, s70
    s_add_u32 s70, s70, 1024
    buffer_load_dwordx4 v12, s[72:75], s47 offen nt lds
    s_add_u32 s47, s47, 1280
    s_mov_b32 m0, s70
    s_add_u32 s70, s70, 1024
    buffer_load_dwordx4 v12, s[72:75], s47 offen nt lds
    s_add_u32 s47, s47, 1793280
    s_add_u32 s52, s52, 1
    s_cmp_lt_u32 s52, 2
    s_cbranch_scc1 L_awo
    s_waitcnt vmcnt(30)
    s_branch L_ago
L_a1:
    s_bitcmp0_b32 s69, 1
    s_cbranch_scc1 L_ago
    v_lshrrev_b32 v12, 2, v1
    v_and_b32 v14, 3, v1
    v_mul_u32_u24 v12, 12288, v12
    v_lshl_add_u32 v12, v14, 4, v12
    s_mov_b32 s74, 1966080
    s_mov_b32 s72, s16
    s_mov_b32 s73, s17
    s_lshl_b32 s47, s71, 6
    s_mov_b32 s52, 0
L_agw0:
    s_mov_b32 m0, s70
    s_add_u32 s70, s70, 1024
    buffer_load_dwordx4 v12, s[72:75], s47 offen nt lds
    s_add_u32 s47, s47, 3072
    s_mov_b32 m0, s70
    s_add_u32 s70, s70, 1024
    buffer_load_dwordx4 v12, s[72:75], s47 offen nt lds
    s_add_u32 s47, s47, 3072
    s_mov_b32 m0, s70
    s_add_u32 s70, s70, 1024
    buffer_load_dwordx4 v12, s[72:75], s47 offen nt lds
    s_add_u32 s47, s47, 3072
    s_mov_b32 m0, s70
    s_add_u32 s70, s70, 1024
    buffer_load_dwordx4 v12, s[72:75], s47 offen nt lds
    s_add_u32 s47, s47, 187392
    s_waitcnt vmcnt(48)
    s_add_u32 s52, s52, 1
    s_cmp_lt_u32 s52, 10
    s_cbranch_scc1 L_agw0
    s_mov_b32 s72, s18
    s_mov_b32 s73, s19
    s_lshl_b32 s47, s71, 6
    s_mov_b32 s52, 0
L_agw1:
    s_mov_b32 m0, s70
    s_add_u32 s70, s70, 1024
    buffer_load_dwordx4 v12, s[72:75], s47 offen nt lds
    s_add_u32 s47, s47, 3072
    s_mov_b32 m0, s70
    s_add_u32 s70, s70, 1024
    buffer_load_dwordx4 v12, s[72:75], s47 offen nt lds
    s_add_u32 s47, s47, 3072
    s_mov_b32 m0, s70
    s_add_u32 s70, s70, 1024
    buffer_load_dwordx4 v12, s[72:75], s47 offen nt lds
    s_add_u32 s47, s47, 3072
    s_mov_b32 m0, s70
    s_add_u32 s70, s70, 1024
    buffer_load_dwordx4 v12, s[72:75], s47 offen nt lds
    s_add_u32 s47, s47, 187392
    s_waitcnt vmcnt(48)
    s_add_u32 s52, s52, 1
    s_cmp_lt_u32 s52, 6
    s_cbranch_scc1 L_agw1
    s_waitcnt vmcnt(12)
L_ago:
    v_mov_b32 v13, 1
    ds_write_b32 v10, v13 offset:60
    s_lshl_b32 s46, s2, 7
    s_add_u32 s46, s46, 2097152
    v_mov_b32 v5, s46
    v_max_u32 v11, 1, v8
    v_add_u32 v12, s28, v11
    v_and_b32 v12, 7, v12
    v_mul_u32_u24 v13, 5, v11
    v_add_u32 v13, s29, v13
    v_and_b32 v13, 31, v13
    v_lshl_add_u32 v12, v13, 3, v12
    v_lshlrev_b32 v12, 7, v12
    v_add_u32 v6, 2097152, v12
    s_mov_b32 s46, 32
    v_writelane_b32 v21, s46, 0
    s_mov_b32 s46, 64
    v_writelane_b32 v21, s46, 1
    s_mov_b32 s46, 96
    v_writelane_b32 v21, s46, 2
    s_mov_b32 s46, 128
    v_writelane_b32 v21, s46, 3
    s_mov_b32 s46, 160
    v_writelane_b32 v21, s46, 4
    s_mov_b32 s46, 190
    v_writelane_b32 v21, s46, 5
    s_mov_b32 s46, 216
    v_writelane_b32 v21, s46, 6
    s_mov_b32 s46, 236
    v_writelane_b32 v21, s46, 7
    s_mov_b32 s46, 4352
    v_writelane_b32 v24, s46, 0
    s_mov_b32 s46, 256
    v_writelane_b32 v24, s46, 1
    s_mov_b32 s46, 0
    v_writelane_b32 v24, s46, 2
    s_mov_b32 s46, 0
    v_writelane_b32 v24, s46, 3
    s_mov_b32 s46, 17
    v_writelane_b32 v24, s46, 4
    s_mov_b32 s46, 85
    v_writelane_b32 v24, s46, 5
    s_mov_b32 s46, 119
    v_writelane_b32 v24, s46, 6
    s_mov_b32 s46, 255
    v_writelane_b32 v24, s46, 7
    s_mov_b32 s46, 65280
    s_bitcmp1_b32 s69, 0
    s_cselect_b32 s46, 0, s46
    s_bitcmp1_b32 s69, 1
    s_cselect_b32 s46, 255, s46
    v_mov_b32 v20, s46
    ds_write_b32 v10, v20 offset:56
    s_waitcnt vmcnt(0) lgkmcnt(0)
    s_add_u32 s31, s31, 1
    v_mov_b32 v15, s31
    s_mov_b32 s53, 0
    s_barrier
L_c0:
    v_readlane_b32 s52, v21, s53
L_c:
    ds_read_b128 v[16:19], v10 offset:0
    s_waitcnt lgkmcnt(0)
    v_add3_u32 v16, v16, v17, v18
    v_add_u32 v16, v16, v19
    s_nop 0
    v_readfirstlane_b32 s46, v16
    s_nop 0
    s_cmp_ge_u32 s46, s52
    s_cbranch_scc1 L_c_go
    s_sub_u32 s44, s44, 1
    s_cmp_eq_u32 s44, 0
    s_cbranch_scc1 L_exit
    s_sleep 4
    s_branch L_c
L_c_go:
    v_mov_b32 v14, s52
    s_mov_b64 exec, 1
    global_store_dwordx2 v5, v[14:15], s[26:27] sc1
    s_mov_b64 exec, 0xfe
    global_load_dwordx2 v[22:23], v6, s[26:27] sc1
    s_waitcnt vmcnt(0)
    v_cmp_eq_u32 vcc, s31, v23
    v_cmp_le_u32 s[46:47], s52, v22
    s_nop 0
    s_and_b64 s[46:47], s[46:47], vcc
    s_mov_b64 exec, -1
    s_bcnt1_i32_b64 s46, s[46:47]
    v_readlane_b32 s46, v24, s46
    s_nop 1
    v_mov_b32 v20, s46
    ds_write_b32 v10, v20 offset:56
    s_add_u32 s53, s53, 1
    s_cmp_lt_u32 s53, 8
    s_cbranch_scc1 L_c0
    s_waitcnt lgkmcnt(0)
    s_branch L_fin
.section .rodata,"a"
.p2align 6
.amdhsa_kernel sequential_preLN__mha_block_cached__swiglu_ffn__decode_kernel
.amdhsa_next_free_vgpr 256
.amdhsa_next_free_sgpr 102
.amdhsa_accum_offset 256
.amdhsa_group_segment_fixed_size 0
.amdhsa_kernarg_size 96
.amdhsa_user_sgpr_count 2
.amdhsa_user_sgpr_kernarg_segment_ptr 1
.amdhsa_system_sgpr_workgroup_id_x 1
.amdhsa_float_denorm_mode_32 3
.end_amdhsa_kernel
```
